```python
import torch

def _softmax(x, axis=-1):
    return torch.softmax(x, dim=axis)
def _gelu(x):
    return torch.nn.functional.gelu(x, approximate="tanh")
def _silu(x):
    return torch.nn.functional.silu(x)
def _sigmoid(x):
    return torch.sigmoid(x)
def _layernorm(x, axis=-1, eps=1e-5):
    m = x.mean(dim=axis, keepdim=True)
    v = x.var(dim=axis, keepdim=True, unbiased=False)
    return (x - m) / torch.sqrt(v + eps)
def _scatter_add(tgt, idx, src, axis=0):
    return tgt.clone().index_add_(axis, idx, src)
def _segment_sum(src, seg, n):
    out = torch.zeros((n,) + src.shape[1:], dtype=src.dtype)
    return out.index_add_(0, seg, src)
def _pad(x, pw):
    flat = tuple(v for pair in reversed(pw) for v in pair)
    return torch.nn.functional.pad(x, flat)

kernel_name = 'standalone__mha_block_cached__near_ridge'

def setup_inputs():

    _w = (lambda a: (lambda t: t.to(torch.bfloat16) if t.is_floating_point() else t)(torch.as_tensor(a)))
    B, Sq, D = 8, 128, 1024
    H, Sk, Dh = 32, 512, 128
    return {
        "x": _w((lambda *s: torch.randn(*s, dtype=torch.bfloat16) * 0.8)(B, Sq, D)),
        "k_cache": _w((lambda *s: torch.randn(*s, dtype=torch.bfloat16) * 0.8)(B, H, Sk, Dh)),
        "v_cache": _w((lambda *s: torch.randn(*s, dtype=torch.bfloat16) * 0.05)(B, H, Sk, Dh)),
        "wq": _w((lambda *s: torch.randn(*s, dtype=torch.bfloat16) * 0.8)(D, H * Dh) * (D ** -0.5)),
        "wo": _w((lambda *s: torch.randn(*s, dtype=torch.bfloat16) * 0.05)(H * Dh, D) * ((H * Dh) ** -0.5)),
    }

def reference(x, k_cache, v_cache, wq, wo):
    B, Sq, D = x.shape
    H, Dh = 32, 128
    q = (lambda x, *d: x.permute(*d))((x @ wq).reshape(B, Sq, H, Dh), 0, 2, 1, 3)
    scores = torch.einsum("bhqd,bhkd->bhqk", q, k_cache) * (Dh ** -0.5)
    p = _softmax(scores, axis=-1)
    o = torch.einsum("bhqk,bhkd->bhqd", p, v_cache)
    return (lambda x, *d: x.permute(*d))(o, 0, 2, 1, 3).reshape(B, Sq, H * Dh) @ wo
```

```asm
; @launch grid=(256,1,1) block=(448,1,1) lds=163840
.amdgcn_target "amdgcn-amd-amdhsa--gfx950"
.text
.globl standalone__mha_block_cached__near_ridge_kernel
.p2align 8
.type standalone__mha_block_cached__near_ridge_kernel,@function
standalone__mha_block_cached__near_ridge_kernel:
  s_cmp_ge_u32 s2, 256
  s_cbranch_scc1 L_END
  s_load_dwordx16 s[4:19], s[0:1], 0
  v_lshrrev_b32 v1, 6, v0
  v_and_b32 v0, 63, v0
  v_readfirstlane_b32 s20, v1
  s_and_b32 s21, s2, 7
  s_lshr_b32 s22, s2, 3
  s_and_b32 s23, s22, 3
  s_lshr_b32 s24, s22, 2
  s_lshl_b32 s25, s21, 2
  s_add_u32 s25, s25, s23
  s_lshr_b32 s75, s2, 3
  s_add_u32 s75, s75, s2
  s_and_b32 s75, s75, 7
  s_add_u32 s60, s24, s23
  s_and_b32 s27, s21, 3
  s_and_b32 s67, s22, 7
  s_lshr_b32 s53, s22, 4
  s_lshl_b32 s53, s53, 1
  s_lshr_b32 s54, s21, 2
  s_add_u32 s53, s53, s54
  s_lshl_b32 s53, s53, 1
  s_bfe_u32 s54, s22, 0x10003
  s_add_u32 s53, s53, s54
  s_lshl_b32 s26, s53, 3
  s_add_u32 s26, s26, s67
  s_lshr_b32 s54, s22, 3
  s_lshl_b32 s54, s54, 1
  s_add_u32 s79, s67, s54
  s_cmp_lt_u32 s20, 4
  s_cbranch_scc1 L_COMPUTE
  s_cmp_eq_u32 s20, 5
  s_cbranch_scc1 L_LW
  s_cmp_eq_u32 s20, 6
  s_cbranch_scc1 L_LH
  v_lshrrev_b32 v1, 3, v0
  v_lshrrev_b32 v2, 4, v0
  v_and_b32 v3, 7, v0
  v_add_u32 v4, 0, v2
  v_xor_b32 v4, v4, v3
  v_add_u32 v5, 0, v1
  v_lshlrev_b32 v5, 11, v5
  v_lshl_add_u32 v5, v4, 4, v5
  v_subrev_u32 v16, 0, v5
  v_add_u32 v4, 4, v2
  v_xor_b32 v4, v4, v3
  v_add_u32 v5, 8, v1
  v_lshlrev_b32 v5, 11, v5
  v_lshl_add_u32 v5, v4, 4, v5
  v_subrev_u32 v17, 1024, v5
  v_add_u32 v4, 0, v2
  v_xor_b32 v4, v4, v3
  v_add_u32 v5, 16, v1
  v_lshlrev_b32 v5, 11, v5
  v_lshl_add_u32 v5, v4, 4, v5
  v_subrev_u32 v18, 2048, v5
  v_add_u32 v4, 4, v2
  v_xor_b32 v4, v4, v3
  v_add_u32 v5, 24, v1
  v_lshlrev_b32 v5, 11, v5
  v_lshl_add_u32 v5, v4, 4, v5
  v_subrev_u32 v19, 3072, v5
  s_lshl_b32 s58, s24, 18
  s_waitcnt lgkmcnt(0)
  s_mov_b32 s28, s4
  s_mov_b32 s29, s5
  s_mov_b32 s30, 0x200000
  s_mov_b32 s31, 0x20000
  s_mov_b32 s62, 0
  s_mov_b32 s63, 0
  s_mov_b32 s57, 0
L_X1_P:
  s_add_u32 s55, s60, s62
  s_and_b32 s55, s55, 3
  s_and_b32 s56, s62, 12
  s_or_b32 s55, s55, s56
  s_lshl_b32 s55, s55, 7
  s_add_u32 s55, s55, s58
  s_add_u32 m0, s63, 0
  s_add_u32 s56, s55, 0
  buffer_load_dwordx4 v16, s[28:31], s56 offen offset:0  lds
  buffer_load_dwordx4 v17, s[28:31], s56 offen offset:1024  lds
  buffer_load_dwordx4 v18, s[28:31], s56 offen offset:2048  lds
  buffer_load_dwordx4 v19, s[28:31], s56 offen offset:3072  lds
  s_add_u32 m0, s63, 4096
  s_add_u32 s56, s55, 65536
  buffer_load_dwordx4 v16, s[28:31], s56 offen offset:0  lds
  buffer_load_dwordx4 v17, s[28:31], s56 offen offset:1024  lds
  buffer_load_dwordx4 v18, s[28:31], s56 offen offset:2048  lds
  buffer_load_dwordx4 v19, s[28:31], s56 offen offset:3072  lds
  s_add_u32 m0, s63, 8192
  s_add_u32 s56, s55, 131072
  buffer_load_dwordx4 v16, s[28:31], s56 offen offset:0  lds
  buffer_load_dwordx4 v17, s[28:31], s56 offen offset:1024  lds
  buffer_load_dwordx4 v18, s[28:31], s56 offen offset:2048  lds
  buffer_load_dwordx4 v19, s[28:31], s56 offen offset:3072  lds
  s_add_u32 m0, s63, 12288
  s_add_u32 s56, s55, 196608
  buffer_load_dwordx4 v16, s[28:31], s56 offen offset:0  lds
  buffer_load_dwordx4 v17, s[28:31], s56 offen offset:1024  lds
  buffer_load_dwordx4 v18, s[28:31], s56 offen offset:2048  lds
  buffer_load_dwordx4 v19, s[28:31], s56 offen offset:3072  lds
  s_add_u32 s62, s62, 1
  s_add_u32 s63, s63, 16384
  s_cmp_eq_u32 s63, 49152
  s_cselect_b32 s63, s57, s63
  s_cmp_lt_u32 s62, 2
  s_cbranch_scc1 L_X1_P
  s_waitcnt vmcnt(16)
  s_barrier
  s_add_u32 s55, s60, s62
  s_and_b32 s55, s55, 3
  s_and_b32 s56, s62, 12
  s_or_b32 s55, s55, s56
  s_lshl_b32 s55, s55, 7
  s_add_u32 s55, s55, s58
  s_add_u32 m0, s63, 0
  s_add_u32 s56, s55, 0
  buffer_load_dwordx4 v16, s[28:31], s56 offen offset:0  lds
  buffer_load_dwordx4 v17, s[28:31], s56 offen offset:1024  lds
  buffer_load_dwordx4 v18, s[28:31], s56 offen offset:2048  lds
  buffer_load_dwordx4 v19, s[28:31], s56 offen offset:3072  lds
  s_add_u32 m0, s63, 4096
  s_add_u32 s56, s55, 65536
  buffer_load_dwordx4 v16, s[28:31], s56 offen offset:0  lds
  buffer_load_dwordx4 v17, s[28:31], s56 offen offset:1024  lds
  buffer_load_dwordx4 v18, s[28:31], s56 offen offset:2048  lds
  buffer_load_dwordx4 v19, s[28:31], s56 offen offset:3072  lds
  s_add_u32 m0, s63, 8192
  s_add_u32 s56, s55, 131072
  buffer_load_dwordx4 v16, s[28:31], s56 offen offset:0  lds
  buffer_load_dwordx4 v17, s[28:31], s56 offen offset:1024  lds
  buffer_load_dwordx4 v18, s[28:31], s56 offen offset:2048  lds
  buffer_load_dwordx4 v19, s[28:31], s56 offen offset:3072  lds
  s_add_u32 m0, s63, 12288
  s_add_u32 s56, s55, 196608
  buffer_load_dwordx4 v16, s[28:31], s56 offen offset:0  lds
  buffer_load_dwordx4 v17, s[28:31], s56 offen offset:1024  lds
  buffer_load_dwordx4 v18, s[28:31], s56 offen offset:2048  lds
  buffer_load_dwordx4 v19, s[28:31], s56 offen offset:3072  lds
  s_add_u32 s62, s62, 1
  s_add_u32 s63, s63, 16384
  s_cmp_eq_u32 s63, 49152
  s_cselect_b32 s63, s57, s63
  s_waitcnt vmcnt(16)
  s_barrier
L_X1_L:
  s_add_u32 s55, s60, s62
  s_and_b32 s55, s55, 3
  s_and_b32 s56, s62, 12
  s_or_b32 s55, s55, s56
  s_lshl_b32 s55, s55, 7
  s_add_u32 s55, s55, s58
  s_add_u32 m0, s63, 0
  s_add_u32 s56, s55, 0
  buffer_load_dwordx4 v16, s[28:31], s56 offen offset:0  lds
  buffer_load_dwordx4 v17, s[28:31], s56 offen offset:1024  lds
  buffer_load_dwordx4 v18, s[28:31], s56 offen offset:2048  lds
  buffer_load_dwordx4 v19, s[28:31], s56 offen offset:3072  lds
  s_add_u32 m0, s63, 4096
  s_add_u32 s56, s55, 65536
  buffer_load_dwordx4 v16, s[28:31], s56 offen offset:0  lds
  buffer_load_dwordx4 v17, s[28:31], s56 offen offset:1024  lds
  buffer_load_dwordx4 v18, s[28:31], s56 offen offset:2048  lds
  buffer_load_dwordx4 v19, s[28:31], s56 offen offset:3072  lds
  s_add_u32 m0, s63, 8192
  s_add_u32 s56, s55, 131072
  buffer_load_dwordx4 v16, s[28:31], s56 offen offset:0  lds
  buffer_load_dwordx4 v17, s[28:31], s56 offen offset:1024  lds
  buffer_load_dwordx4 v18, s[28:31], s56 offen offset:2048  lds
  buffer_load_dwordx4 v19, s[28:31], s56 offen offset:3072  lds
  s_add_u32 m0, s63, 12288
  s_add_u32 s56, s55, 196608
  buffer_load_dwordx4 v16, s[28:31], s56 offen offset:0  lds
  buffer_load_dwordx4 v17, s[28:31], s56 offen offset:1024  lds
  buffer_load_dwordx4 v18, s[28:31], s56 offen offset:2048  lds
  buffer_load_dwordx4 v19, s[28:31], s56 offen offset:3072  lds
  s_add_u32 s62, s62, 1
  s_add_u32 s63, s63, 16384
  s_cmp_eq_u32 s63, 49152
  s_cselect_b32 s63, s57, s63
  s_waitcnt vmcnt(16)
  s_barrier
  s_cmp_lt_u32 s62, 16
  s_cbranch_scc1 L_X1_L
  s_waitcnt vmcnt(0)
  s_barrier
  s_barrier
  v_lshlrev_b32 v16, 4, v0
  s_mov_b32 s60, s79
  s_lshl_b32 s58, s53, 5
  s_lshl_b32 s54, s27, 3
  s_add_u32 s58, s58, s54
  s_lshl_b32 s58, s58, 15
  s_mov_b32 s28, s18
  s_mov_b32 s29, s19
  s_mov_b32 s30, 0x800000
  s_mov_b32 s31, 0x20000
  s_barrier
  s_barrier
  s_barrier
  s_barrier
  s_barrier
  s_barrier
  s_barrier
  s_barrier
  s_barrier
  s_barrier
  s_barrier
  s_barrier
  s_barrier
  s_barrier
  s_barrier
  s_barrier
  s_barrier
  s_barrier
  s_barrier
  s_mov_b32 s62, 0
  s_mov_b32 s63, 0
  s_mov_b32 s57, 0
L_X3_P:
  s_add_u32 s55, s60, s62
  s_and_b32 s55, s55, 7
  s_and_b32 s56, s62, 8
  s_or_b32 s55, s55, s56
  s_lshr_b32 s56, s55, 1
  s_lshl_b32 s56, s56, 15
  s_and_b32 s55, s55, 1
  s_lshl_b32 s55, s55, 12
  s_add_u32 s55, s55, s56
  s_add_u32 s55, s55, s58
  s_add_u32 m0, s63, 0
  s_add_u32 s56, s55, 0
  buffer_load_dwordx4 v16, s[28:31], s56 offen offset:0 sc1 lds
  buffer_load_dwordx4 v16, s[28:31], s56 offen offset:1024 sc1 lds
  buffer_load_dwordx4 v16, s[28:31], s56 offen offset:2048 sc1 lds
  buffer_load_dwordx4 v16, s[28:31], s56 offen offset:3072 sc1 lds
  s_add_u32 m0, s63, 4096
  s_add_u32 s56, s55, 8192
  buffer_load_dwordx4 v16, s[28:31], s56 offen offset:0 sc1 lds
  buffer_load_dwordx4 v16, s[28:31], s56 offen offset:1024 sc1 lds
  buffer_load_dwordx4 v16, s[28:31], s56 offen offset:2048 sc1 lds
  buffer_load_dwordx4 v16, s[28:31], s56 offen offset:3072 sc1 lds
  s_add_u32 m0, s63, 8192
  s_add_u32 s56, s55, 16384
  buffer_load_dwordx4 v16, s[28:31], s56 offen offset:0 sc1 lds
  buffer_load_dwordx4 v16, s[28:31], s56 offen offset:1024 sc1 lds
  buffer_load_dwordx4 v16, s[28:31], s56 offen offset:2048 sc1 lds
  buffer_load_dwordx4 v16, s[28:31], s56 offen offset:3072 sc1 lds
  s_add_u32 m0, s63, 12288
  s_add_u32 s56, s55, 24576
  buffer_load_dwordx4 v16, s[28:31], s56 offen offset:0 sc1 lds
  buffer_load_dwordx4 v16, s[28:31], s56 offen offset:1024 sc1 lds
  buffer_load_dwordx4 v16, s[28:31], s56 offen offset:2048 sc1 lds
  buffer_load_dwordx4 v16, s[28:31], s56 offen offset:3072 sc1 lds
  s_add_u32 s62, s62, 1
  s_add_u32 s63, s63, 16384
  s_cmp_eq_u32 s63, 49152
  s_cselect_b32 s63, s57, s63
  s_cmp_lt_u32 s62, 2
  s_cbranch_scc1 L_X3_P
  s_waitcnt vmcnt(16)
  s_barrier
  s_add_u32 s55, s60, s62
  s_and_b32 s55, s55, 7
  s_and_b32 s56, s62, 8
  s_or_b32 s55, s55, s56
  s_lshr_b32 s56, s55, 1
  s_lshl_b32 s56, s56, 15
  s_and_b32 s55, s55, 1
  s_lshl_b32 s55, s55, 12
  s_add_u32 s55, s55, s56
  s_add_u32 s55, s55, s58
  s_add_u32 m0, s63, 0
  s_add_u32 s56, s55, 0
  buffer_load_dwordx4 v16, s[28:31], s56 offen offset:0 sc1 lds
  buffer_load_dwordx4 v16, s[28:31], s56 offen offset:1024 sc1 lds
  buffer_load_dwordx4 v16, s[28:31], s56 offen offset:2048 sc1 lds
  buffer_load_dwordx4 v16, s[28:31], s56 offen offset:3072 sc1 lds
  s_add_u32 m0, s63, 4096
  s_add_u32 s56, s55, 8192
  buffer_load_dwordx4 v16, s[28:31], s56 offen offset:0 sc1 lds
  buffer_load_dwordx4 v16, s[28:31], s56 offen offset:1024 sc1 lds
  buffer_load_dwordx4 v16, s[28:31], s56 offen offset:2048 sc1 lds
  buffer_load_dwordx4 v16, s[28:31], s56 offen offset:3072 sc1 lds
  s_add_u32 m0, s63, 8192
  s_add_u32 s56, s55, 16384
  buffer_load_dwordx4 v16, s[28:31], s56 offen offset:0 sc1 lds
  buffer_load_dwordx4 v16, s[28:31], s56 offen offset:1024 sc1 lds
  buffer_load_dwordx4 v16, s[28:31], s56 offen offset:2048 sc1 lds
  buffer_load_dwordx4 v16, s[28:31], s56 offen offset:3072 sc1 lds
  s_add_u32 m0, s63, 12288
  s_add_u32 s56, s55, 24576
  buffer_load_dwordx4 v16, s[28:31], s56 offen offset:0 sc1 lds
  buffer_load_dwordx4 v16, s[28:31], s56 offen offset:1024 sc1 lds
  buffer_load_dwordx4 v16, s[28:31], s56 offen offset:2048 sc1 lds
  buffer_load_dwordx4 v16, s[28:31], s56 offen offset:3072 sc1 lds
  s_add_u32 s62, s62, 1
  s_add_u32 s63, s63, 16384
  s_cmp_eq_u32 s63, 49152
  s_cselect_b32 s63, s57, s63
  s_waitcnt vmcnt(16)
  s_barrier
L_X3_L:
  s_add_u32 s55, s60, s62
  s_and_b32 s55, s55, 7
  s_and_b32 s56, s62, 8
  s_or_b32 s55, s55, s56
  s_lshr_b32 s56, s55, 1
  s_lshl_b32 s56, s56, 15
  s_and_b32 s55, s55, 1
  s_lshl_b32 s55, s55, 12
  s_add_u32 s55, s55, s56
  s_add_u32 s55, s55, s58
  s_add_u32 m0, s63, 0
  s_add_u32 s56, s55, 0
  buffer_load_dwordx4 v16, s[28:31], s56 offen offset:0 sc1 lds
  buffer_load_dwordx4 v16, s[28:31], s56 offen offset:1024 sc1 lds
  buffer_load_dwordx4 v16, s[28:31], s56 offen offset:2048 sc1 lds
  buffer_load_dwordx4 v16, s[28:31], s56 offen offset:3072 sc1 lds
  s_add_u32 m0, s63, 4096
  s_add_u32 s56, s55, 8192
  buffer_load_dwordx4 v16, s[28:31], s56 offen offset:0 sc1 lds
  buffer_load_dwordx4 v16, s[28:31], s56 offen offset:1024 sc1 lds
  buffer_load_dwordx4 v16, s[28:31], s56 offen offset:2048 sc1 lds
  buffer_load_dwordx4 v16, s[28:31], s56 offen offset:3072 sc1 lds
  s_add_u32 m0, s63, 8192
  s_add_u32 s56, s55, 16384
  buffer_load_dwordx4 v16, s[28:31], s56 offen offset:0 sc1 lds
  buffer_load_dwordx4 v16, s[28:31], s56 offen offset:1024 sc1 lds
  buffer_load_dwordx4 v16, s[28:31], s56 offen offset:2048 sc1 lds
  buffer_load_dwordx4 v16, s[28:31], s56 offen offset:3072 sc1 lds
  s_add_u32 m0, s63, 12288
  s_add_u32 s56, s55, 24576
  buffer_load_dwordx4 v16, s[28:31], s56 offen offset:0 sc1 lds
  buffer_load_dwordx4 v16, s[28:31], s56 offen offset:1024 sc1 lds
  buffer_load_dwordx4 v16, s[28:31], s56 offen offset:2048 sc1 lds
  buffer_load_dwordx4 v16, s[28:31], s56 offen offset:3072 sc1 lds
  s_add_u32 s62, s62, 1
  s_add_u32 s63, s63, 16384
  s_cmp_eq_u32 s63, 49152
  s_cselect_b32 s63, s57, s63
  s_waitcnt vmcnt(16)
  s_barrier
  s_cmp_lt_u32 s62, 16
  s_cbranch_scc1 L_X3_L
  s_waitcnt vmcnt(0)
  s_barrier
  s_barrier
  s_endpgm
L_LW:
  v_lshrrev_b32 v1, 4, v0
  v_and_b32 v2, 15, v0
  v_lshlrev_b32 v3, 2, v1
  v_xor_b32 v3, v3, v2
  v_add_u32 v5, 0, v1
  v_lshlrev_b32 v5, 13, v5
  v_lshl_add_u32 v5, v3, 4, v5
  v_subrev_u32 v16, 0, v5
  v_add_u32 v5, 4, v1
  v_lshlrev_b32 v5, 13, v5
  v_lshl_add_u32 v5, v3, 4, v5
  v_subrev_u32 v17, 1024, v5
  v_add_u32 v5, 8, v1
  v_lshlrev_b32 v5, 13, v5
  v_lshl_add_u32 v5, v3, 4, v5
  v_subrev_u32 v18, 2048, v5
  v_add_u32 v5, 12, v1
  v_lshlrev_b32 v5, 13, v5
  v_lshl_add_u32 v5, v3, 4, v5
  v_subrev_u32 v19, 3072, v5
  s_lshl_b32 s58, s25, 8
  s_waitcnt lgkmcnt(0)
  s_mov_b32 s32, s10
  s_mov_b32 s33, s11
  s_mov_b32 s34, 0x800000
  s_mov_b32 s35, 0x20000
  s_mov_b32 s62, 0
  s_mov_b32 s63, 49152
  s_mov_b32 s57, 49152
L_W1_P:
  s_add_u32 s55, s60, s62
  s_and_b32 s55, s55, 3
  s_and_b32 s56, s62, 12
  s_or_b32 s55, s55, s56
  s_lshl_b32 s55, s55, 19
  s_add_u32 s55, s55, s58
  s_add_u32 m0, s63, 0
  s_add_u32 s56, s55, 0
  buffer_load_dwordx4 v16, s[32:35], s56 offen offset:0  lds
  buffer_load_dwordx4 v17, s[32:35], s56 offen offset:1024  lds
  buffer_load_dwordx4 v18, s[32:35], s56 offen offset:2048  lds
  buffer_load_dwordx4 v19, s[32:35], s56 offen offset:3072  lds
  s_add_u32 m0, s63, 4096
  s_add_u32 s56, s55, 131072
  buffer_load_dwordx4 v16, s[32:35], s56 offen offset:0  lds
  buffer_load_dwordx4 v17, s[32:35], s56 offen offset:1024  lds
  buffer_load_dwordx4 v18, s[32:35], s56 offen offset:2048  lds
  buffer_load_dwordx4 v19, s[32:35], s56 offen offset:3072  lds
  s_add_u32 m0, s63, 8192
  s_add_u32 s56, s55, 262144
  buffer_load_dwordx4 v16, s[32:35], s56 offen offset:0  lds
  buffer_load_dwordx4 v17, s[32:35], s56 offen offset:1024  lds
  buffer_load_dwordx4 v18, s[32:35], s56 offen offset:2048  lds
  buffer_load_dwordx4 v19, s[32:35], s56 offen offset:3072  lds
  s_add_u32 m0, s63, 12288
  s_add_u32 s56, s55, 393216
  buffer_load_dwordx4 v16, s[32:35], s56 offen offset:0  lds
  buffer_load_dwordx4 v17, s[32:35], s56 offen offset:1024  lds
  buffer_load_dwordx4 v18, s[32:35], s56 offen offset:2048  lds
  buffer_load_dwordx4 v19, s[32:35], s56 offen offset:3072  lds
  s_add_u32 s62, s62, 1
  s_add_u32 s63, s63, 16384
  s_cmp_eq_u32 s63, 98304
  s_cselect_b32 s63, s57, s63
  s_cmp_lt_u32 s62, 2
  s_cbranch_scc1 L_W1_P
  s_waitcnt vmcnt(16)
  s_barrier
  s_add_u32 s55, s60, s62
  s_and_b32 s55, s55, 3
  s_and_b32 s56, s62, 12
  s_or_b32 s55, s55, s56
  s_lshl_b32 s55, s55, 19
  s_add_u32 s55, s55, s58
  s_add_u32 m0, s63, 0
  s_add_u32 s56, s55, 0
  buffer_load_dwordx4 v16, s[32:35], s56 offen offset:0  lds
  buffer_load_dwordx4 v17, s[32:35], s56 offen offset:1024  lds
  buffer_load_dwordx4 v18, s[32:35], s56 offen offset:2048  lds
  buffer_load_dwordx4 v19, s[32:35], s56 offen offset:3072  lds
  s_add_u32 m0, s63, 4096
  s_add_u32 s56, s55, 131072
  buffer_load_dwordx4 v16, s[32:35], s56 offen offset:0  lds
  buffer_load_dwordx4 v17, s[32:35], s56 offen offset:1024  lds
  buffer_load_dwordx4 v18, s[32:35], s56 offen offset:2048  lds
  buffer_load_dwordx4 v19, s[32:35], s56 offen offset:3072  lds
  s_add_u32 m0, s63, 8192
  s_add_u32 s56, s55, 262144
  buffer_load_dwordx4 v16, s[32:35], s56 offen offset:0  lds
  buffer_load_dwordx4 v17, s[32:35], s56 offen offset:1024  lds
  buffer_load_dwordx4 v18, s[32:35], s56 offen offset:2048  lds
  buffer_load_dwordx4 v19, s[32:35], s56 offen offset:3072  lds
  s_add_u32 m0, s63, 12288
  s_add_u32 s56, s55, 393216
  buffer_load_dwordx4 v16, s[32:35], s56 offen offset:0  lds
  buffer_load_dwordx4 v17, s[32:35], s56 offen offset:1024  lds
  buffer_load_dwordx4 v18, s[32:35], s56 offen offset:2048  lds
  buffer_load_dwordx4 v19, s[32:35], s56 offen offset:3072  lds
  s_add_u32 s62, s62, 1
  s_add_u32 s63, s63, 16384
  s_cmp_eq_u32 s63, 98304
  s_cselect_b32 s63, s57, s63
  s_waitcnt vmcnt(16)
  s_barrier
L_W1_L:
  s_add_u32 s55, s60, s62
  s_and_b32 s55, s55, 3
  s_and_b32 s56, s62, 12
  s_or_b32 s55, s55, s56
  s_lshl_b32 s55, s55, 19
  s_add_u32 s55, s55, s58
  s_add_u32 m0, s63, 0
  s_add_u32 s56, s55, 0
  buffer_load_dwordx4 v16, s[32:35], s56 offen offset:0  lds
  buffer_load_dwordx4 v17, s[32:35], s56 offen offset:1024  lds
  buffer_load_dwordx4 v18, s[32:35], s56 offen offset:2048  lds
  buffer_load_dwordx4 v19, s[32:35], s56 offen offset:3072  lds
  s_add_u32 m0, s63, 4096
  s_add_u32 s56, s55, 131072
  buffer_load_dwordx4 v16, s[32:35], s56 offen offset:0  lds
  buffer_load_dwordx4 v17, s[32:35], s56 offen offset:1024  lds
  buffer_load_dwordx4 v18, s[32:35], s56 offen offset:2048  lds
  buffer_load_dwordx4 v19, s[32:35], s56 offen offset:3072  lds
  s_add_u32 m0, s63, 8192
  s_add_u32 s56, s55, 262144
  buffer_load_dwordx4 v16, s[32:35], s56 offen offset:0  lds
  buffer_load_dwordx4 v17, s[32:35], s56 offen offset:1024  lds
  buffer_load_dwordx4 v18, s[32:35], s56 offen offset:2048  lds
  buffer_load_dwordx4 v19, s[32:35], s56 offen offset:3072  lds
  s_add_u32 m0, s63, 12288
  s_add_u32 s56, s55, 393216
  buffer_load_dwordx4 v16, s[32:35], s56 offen offset:0  lds
  buffer_load_dwordx4 v17, s[32:35], s56 offen offset:1024  lds
  buffer_load_dwordx4 v18, s[32:35], s56 offen offset:2048  lds
  buffer_load_dwordx4 v19, s[32:35], s56 offen offset:3072  lds
  s_add_u32 s62, s62, 1
  s_add_u32 s63, s63, 16384
  s_cmp_eq_u32 s63, 98304
  s_cselect_b32 s63, s57, s63
  s_waitcnt vmcnt(16)
  s_barrier
  s_cmp_lt_u32 s62, 16
  s_cbranch_scc1 L_W1_L
  s_waitcnt vmcnt(0)
  s_barrier
  s_barrier
  v_lshrrev_b32 v1, 4, v0
  v_and_b32 v2, 15, v0
  v_lshlrev_b32 v3, 2, v1
  v_xor_b32 v3, v3, v2
  v_add_u32 v5, 0, v1
  v_lshlrev_b32 v5, 11, v5
  v_lshl_add_u32 v5, v3, 4, v5
  v_subrev_u32 v16, 0, v5
  v_add_u32 v5, 4, v1
  v_lshlrev_b32 v5, 11, v5
  v_lshl_add_u32 v5, v3, 4, v5
  v_subrev_u32 v17, 1024, v5
  v_add_u32 v5, 8, v1
  v_lshlrev_b32 v5, 11, v5
  v_lshl_add_u32 v5, v3, 4, v5
  v_subrev_u32 v18, 2048, v5
  v_add_u32 v5, 12, v1
  v_lshlrev_b32 v5, 11, v5
  v_lshl_add_u32 v5, v3, 4, v5
  v_subrev_u32 v19, 3072, v5
  s_mov_b32 s60, s79
  s_lshl_b32 s58, s27, 21
  s_lshl_b32 s54, s67, 8
  s_add_u32 s58, s58, s54
  s_mov_b32 s32, s12
  s_mov_b32 s33, s13
  s_mov_b32 s34, 0x800000
  s_mov_b32 s35, 0x20000
  s_mov_b32 s62, 0
  s_mov_b32 s63, 49152
  s_mov_b32 s57, 49152
  s_barrier
  s_barrier
  s_barrier
  s_barrier
  s_barrier
  s_barrier
  s_barrier
  s_barrier
  s_barrier
  s_barrier
  s_barrier
  s_barrier
  s_barrier
  s_barrier
  s_barrier
L_W3_P:
  s_add_u32 s55, s60, s62
  s_and_b32 s55, s55, 7
  s_and_b32 s56, s62, 8
  s_or_b32 s55, s55, s56
  s_lshl_b32 s55, s55, 17
  s_add_u32 s55, s55, s58
  s_add_u32 m0, s63, 0
  s_add_u32 s56, s55, 0
  buffer_load_dwordx4 v16, s[32:35], s56 offen offset:0  lds
  buffer_load_dwordx4 v17, s[32:35], s56 offen offset:1024  lds
  buffer_load_dwordx4 v18, s[32:35], s56 offen offset:2048  lds
  buffer_load_dwordx4 v19, s[32:35], s56 offen offset:3072  lds
  s_add_u32 m0, s63, 4096
  s_add_u32 s56, s55, 32768
  buffer_load_dwordx4 v16, s[32:35], s56 offen offset:0  lds
  buffer_load_dwordx4 v17, s[32:35], s56 offen offset:1024  lds
  buffer_load_dwordx4 v18, s[32:35], s56 offen offset:2048  lds
  buffer_load_dwordx4 v19, s[32:35], s56 offen offset:3072  lds
  s_add_u32 m0, s63, 8192
  s_add_u32 s56, s55, 65536
  buffer_load_dwordx4 v16, s[32:35], s56 offen offset:0  lds
  buffer_load_dwordx4 v17, s[32:35], s56 offen offset:1024  lds
  buffer_load_dwordx4 v18, s[32:35], s56 offen offset:2048  lds
  buffer_load_dwordx4 v19, s[32:35], s56 offen offset:3072  lds
  s_add_u32 m0, s63, 12288
  s_add_u32 s56, s55, 98304
  buffer_load_dwordx4 v16, s[32:35], s56 offen offset:0  lds
  buffer_load_dwordx4 v17, s[32:35], s56 offen offset:1024  lds
  buffer_load_dwordx4 v18, s[32:35], s56 offen offset:2048  lds
  buffer_load_dwordx4 v19, s[32:35], s56 offen offset:3072  lds
  s_add_u32 s62, s62, 1
  s_add_u32 s63, s63, 16384
  s_cmp_eq_u32 s63, 98304
  s_cselect_b32 s63, s57, s63
  s_cmp_lt_u32 s62, 3
  s_cbranch_scc1 L_W3_P
  s_barrier
  s_barrier
  s_barrier
  s_barrier
  s_waitcnt vmcnt(0)
  s_barrier
  s_barrier
L_W3_L:
  s_add_u32 s55, s60, s62
  s_and_b32 s55, s55, 7
  s_and_b32 s56, s62, 8
  s_or_b32 s55, s55, s56
  s_lshl_b32 s55, s55, 17
  s_add_u32 s55, s55, s58
  s_add_u32 m0, s63, 0
  s_add_u32 s56, s55, 0
  buffer_load_dwordx4 v16, s[32:35], s56 offen offset:0  lds
  buffer_load_dwordx4 v17, s[32:35], s56 offen offset:1024  lds
  buffer_load_dwordx4 v18, s[32:35], s56 offen offset:2048  lds
  buffer_load_dwordx4 v19, s[32:35], s56 offen offset:3072  lds
  s_add_u32 m0, s63, 4096
  s_add_u32 s56, s55, 32768
  buffer_load_dwordx4 v16, s[32:35], s56 offen offset:0  lds
  buffer_load_dwordx4 v17, s[32:35], s56 offen offset:1024  lds
  buffer_load_dwordx4 v18, s[32:35], s56 offen offset:2048  lds
  buffer_load_dwordx4 v19, s[32:35], s56 offen offset:3072  lds
  s_add_u32 m0, s63, 8192
  s_add_u32 s56, s55, 65536
  buffer_load_dwordx4 v16, s[32:35], s56 offen offset:0  lds
  buffer_load_dwordx4 v17, s[32:35], s56 offen offset:1024  lds
  buffer_load_dwordx4 v18, s[32:35], s56 offen offset:2048  lds
  buffer_load_dwordx4 v19, s[32:35], s56 offen offset:3072  lds
  s_add_u32 m0, s63, 12288
  s_add_u32 s56, s55, 98304
  buffer_load_dwordx4 v16, s[32:35], s56 offen offset:0  lds
  buffer_load_dwordx4 v17, s[32:35], s56 offen offset:1024  lds
  buffer_load_dwordx4 v18, s[32:35], s56 offen offset:2048  lds
  buffer_load_dwordx4 v19, s[32:35], s56 offen offset:3072  lds
  s_add_u32 s62, s62, 1
  s_add_u32 s63, s63, 16384
  s_cmp_eq_u32 s63, 98304
  s_cselect_b32 s63, s57, s63
  s_waitcnt vmcnt(16)
  s_barrier
  s_cmp_lt_u32 s62, 16
  s_cbranch_scc1 L_W3_L
  s_waitcnt vmcnt(0)
  s_barrier
  s_barrier
  s_endpgm
L_LH:
  s_waitcnt lgkmcnt(0)
  s_mov_b32 s48, s18
  s_mov_b32 s49, s19
  s_mov_b32 s50, 0x8000000
  s_mov_b32 s51, 0x20000
  s_mov_b32 s40, s16
  s_mov_b32 s41, s17
  s_mov_b32 s42, 0x100
  s_mov_b32 s43, 0x20000
  s_lshl_b32 s54, s24, 5
  s_add_u32 s54, s54, s25
  s_lshl_b32 s54, s54, 15
  v_mov_b32 v10, s54
  s_lshl_b32 s54, s26, 18
  s_add_u32 s54, s54, 8390656
  v_writelane_b32 v10, s54, 1
  s_mov_b32 s54, 33587200
  v_writelane_b32 v10, s54, 2
  v_cmp_gt_u32 vcc, 3, v0
  s_and_saveexec_b64 s[68:69], vcc
  buffer_load_dword v11, v10, s[48:51], 0 offen sc1
  s_mov_b64 exec, s[68:69]
  s_lshl_b32 s54, s24, 5
  s_add_u32 s54, s54, s25
  s_lshl_b32 s55, s54, 17
  v_mov_b32 v12, 0
  s_add_u32 s36, s6, s55
  s_addc_u32 s37, s7, 0
  s_mov_b32 s38, 0x20000
  s_mov_b32 s39, 0x20000
  buffer_load_dword v13, v12, s[36:39], 0 offen nt
  s_add_u32 s28, s8, s55
  s_addc_u32 s29, s9, 0
  s_mov_b32 s30, 0x20000
  s_mov_b32 s31, 0x20000
  buffer_load_dword v14, v12, s[28:31], 0 offen nt
  s_mov_b32 s32, s12
  s_mov_b32 s33, s13
  s_mov_b32 s34, 0x800000
  s_mov_b32 s35, 0x20000
  s_lshl_b32 s54, s27, 21
  s_lshl_b32 s55, s67, 8
  s_add_u32 s54, s54, s55
  buffer_load_dword v15, v12, s[32:35], s54 offen
  v_mov_b32 v8, 0
  s_cmp_eq_u32 s2, 0
  s_cbranch_scc0 L_NP_S
  s_mov_b32 s54, 33751040
  buffer_load_dword v9, v8, s[48:51], s54 offen sc1
  s_waitcnt vmcnt(0)
  v_add_u32 v9, 1, v9
  v_max_u32 v9, 1, v9
  v_cmp_eq_u32 vcc, 0, v0
  s_and_saveexec_b64 s[68:69], vcc
  buffer_store_dword v9, v8, s[48:51], s54 offen sc1
  buffer_store_dword v9, v8, s[40:43], 0 offen sc1
  s_mov_b64 exec, s[68:69]
L_NP_S:
  s_barrier
  s_barrier
  s_barrier
  s_barrier
  s_barrier
  s_barrier
  s_barrier
  s_barrier
  s_barrier
  s_barrier
  s_barrier
  s_barrier
  s_barrier
  s_barrier
  s_barrier
  s_barrier
  s_barrier
  s_barrier
  s_barrier
  s_barrier
  buffer_load_dword v9, v8, s[40:43], 0 offen sc1
  s_barrier
  s_barrier
  s_barrier
  s_mov_b32 s55, 0
L_N1_L:
  s_waitcnt vmcnt(0)
  v_cmp_ne_u32 vcc, 0, v9
  s_cmp_lg_u64 vcc, 0
  s_cbranch_scc1 L_N1_D
  s_sleep 4
  buffer_load_dword v9, v8, s[40:43], 0 offen sc1
  s_add_u32 s55, s55, 1
  s_cmp_lt_u32 s55, 0x40000
  s_cbranch_scc1 L_N1_L
  s_waitcnt vmcnt(0)
L_N1_D:
  s_nop 1
  v_readfirstlane_b32 s74, v9
  s_barrier
  s_barrier
  s_barrier
  s_barrier
  s_barrier
  s_barrier
  s_barrier
  s_barrier
  s_barrier
  s_barrier
  s_barrier
  s_barrier
  s_lshr_b32 s54, s25, 3
  s_lshl_b32 s55, s24, 2
  s_add_u32 s54, s54, s55
  s_lshl_b32 s54, s54, 7
  s_and_b32 s55, s25, 7
  s_lshl_b32 s55, s55, 4
  s_add_u32 s54, s54, s55
  s_add_u32 s54, s54, 33554432
  v_mov_b32 v1, 0
  v_mov_b32 v2, s74
  v_cmp_eq_u32 vcc, 0, v0
  s_and_saveexec_b64 s[68:69], vcc
  buffer_store_dword v2, v1, s[48:51], s54 offen sc1
  s_mov_b64 exec, s[68:69]
  s_lshl_b32 s54, s53, 2
  s_add_u32 s54, s54, s27
  s_lshl_b32 s54, s54, 7
  s_add_u32 s54, s54, 33554432
  v_lshlrev_b32 v1, 4, v0
  v_cmp_gt_u32 vcc, 8, v0
  s_and_saveexec_b64 s[68:69], vcc
  s_mov_b32 s55, 0
L_HP:
  buffer_load_dword v3, v1, s[48:51], s54 offen sc1
  s_add_u32 s55, s55, 1
  s_waitcnt vmcnt(0)
  v_cmp_eq_u32 vcc, s74, v3
  s_cmp_eq_u32 vcc_lo, 255
  s_cbranch_scc1 L_HP_OK
  s_sleep 2
  s_cmp_lt_u32 s55, 0x40000
  s_cbranch_scc1 L_HP
L_HP_OK:
  s_mov_b64 exec, s[68:69]
  v_mov_b32 v1, 98304
  v_mov_b32 v2, s74
  ds_write_b32 v1, v2
  s_waitcnt lgkmcnt(0)
  s_barrier
  s_endpgm
L_COMPUTE:
  s_and_b32 s56, s20, 1
  s_lshr_b32 s57, s20, 1
  s_lshl_b32 s59, s56, 1
  v_lshrrev_b32 v1, 5, v0
  v_bfe_u32 v2, v0, 4, 1
  v_bfe_u32 v3, v0, 2, 2
  v_and_b32 v4, 1, v0
  v_bfe_u32 v5, v0, 1, 1
  v_lshl_add_u32 v4, v2, 1, v4
  v_mul_u32_u24 v6, 8, v1
  v_add_u32 v6, v6, v3
  v_lshlrev_b32 v6, 8, v6
  v_lshl_add_u32 v6, v5, 3, v6
  v_lshl_add_u32 v6, v4, 4, v6
  s_add_u32 s54, s59, 0
  v_xor_b32 v7, s54, v3
  v_lshl_add_u32 v192, v7, 6, v6
  s_add_u32 s54, s59, 1
  v_xor_b32 v7, s54, v3
  v_lshl_add_u32 v193, v7, 6, v6
  v_add_u32 v192, 49152, v192
  v_add_u32 v193, 49152, v193
  v_lshrrev_b32 v1, 5, v0
  v_bfe_u32 v2, v0, 4, 1
  v_bfe_u32 v3, v0, 2, 2
  v_and_b32 v4, 1, v0
  v_bfe_u32 v5, v0, 1, 1
  v_lshl_add_u32 v4, v2, 1, v4
  v_mul_u32_u24 v6, 4, v1
  v_add_u32 v6, v6, v3
  v_lshlrev_b32 v6, 8, v6
  v_lshl_add_u32 v6, v5, 3, v6
  v_lshl_add_u32 v6, v4, 4, v6
  v_xor_b32 v7, 0, v3
  v_lshl_add_u32 v24, v7, 6, v6
  v_xor_b32 v7, 1, v3
  v_lshl_add_u32 v25, v7, 6, v6
  v_xor_b32 v7, 2, v3
  v_lshl_add_u32 v26, v7, 6, v6
  v_xor_b32 v7, 3, v3
  v_lshl_add_u32 v27, v7, 6, v6
  v_and_b32 v2, 31, v0
  v_lshrrev_b32 v1, 5, v0
  v_bfe_u32 v3, v0, 1, 3
  v_xor_b32 v3, v1, v3
  s_lshl_b32 s54, s57, 13
  v_lshlrev_b32 v4, 7, v2
  v_add_u32 v4, s54, v4
  v_lshl_add_u32 v194, v3, 4, v4
  v_xor_b32 v195, 32, v194
  v_xor_b32 v196, 64, v194
  v_xor_b32 v197, 96, v194
  v_and_b32 v3, 15, v0
  v_xor_b32 v3, v1, v3
  v_lshlrev_b32 v4, 8, v2
  v_lshl_add_u32 v16, v3, 4, v4
  v_xor_b32 v17, 32, v16
  v_xor_b32 v18, 64, v16
  v_xor_b32 v19, 96, v16
  v_xor_b32 v20, 128, v16
  v_xor_b32 v21, 160, v16
  v_xor_b32 v22, 192, v16
  v_xor_b32 v23, 224, v16
  v_lshrrev_b32 v1, 4, v0
  v_and_b32 v2, 15, v0
  v_lshlrev_b32 v3, 8, v1
  v_add_u32 v4, 0, v1
  v_xor_b32 v4, v4, v2
  v_lshl_add_u32 v28, v4, 4, v3
  v_add_u32 v4, 4, v1
  v_xor_b32 v4, v4, v2
  v_lshl_add_u32 v29, v4, 4, v3
  v_add_u32 v4, 8, v1
  v_xor_b32 v4, v4, v2
  v_lshl_add_u32 v30, v4, 4, v3
  v_add_u32 v4, 12, v1
  v_xor_b32 v4, v4, v2
  v_lshl_add_u32 v31, v4, 4, v3
  v_lshlrev_b32 v4, 2, v1
  v_xor_b32 v4, v4, v2
  v_lshl_add_u32 v32, v4, 4, v3
  v_lshlrev_b32 v33, 4, v0
  s_lshl_b32 s61, s20, 12
  s_mov_b32 s52, 0x3e0293ee
  s_mov_b32 s64, 0x41000000
  s_lshl_b32 s54, s24, 5
  s_add_u32 s54, s54, s25
  s_lshl_b32 s55, s54, 17
  s_lshl_b32 s56, s54, 15
  s_waitcnt lgkmcnt(0)
  s_add_u32 s36, s6, s55
  s_addc_u32 s37, s7, 0
  s_mov_b32 s38, 0x20000
  s_mov_b32 s39, 0x20000
  s_add_u32 s40, s8, s55
  s_addc_u32 s41, s9, 0
  s_mov_b32 s42, 0x20000
  s_mov_b32 s43, 0x20000
  s_add_u32 s44, s18, s56
  s_addc_u32 s45, s19, 0
  s_mov_b32 s46, 0x8000
  s_mov_b32 s47, 0x20000
  s_barrier
  ds_read_b64_tr_b16 v[128:129], v192 offset:0
  ds_read_b64_tr_b16 v[130:131], v192 offset:1024
  ds_read_b128 v[136:139], v194 offset:0
  ds_read_b128 v[140:143], v194 offset:4096
  ds_read_b64_tr_b16 v[132:133], v193 offset:0
  ds_read_b64_tr_b16 v[134:135], v193 offset:1024
  ds_read_b64_tr_b16 v[144:145], v192 offset:4096
  ds_read_b64_tr_b16 v[146:147], v192 offset:5120
  ds_read_b128 v[152:155], v195 offset:0
  ds_read_b128 v[156:159], v195 offset:4096
  ds_read_b64_tr_b16 v[148:149], v193 offset:4096
  ds_read_b64_tr_b16 v[150:151], v193 offset:5120
  s_waitcnt lgkmcnt(6)
  v_mfma_f32_32x32x16_bf16 v[64:79], v[128:131], v[136:139], 0
  ds_read_b64_tr_b16 v[160:161], v192 offset:8192
  ds_read_b64_tr_b16 v[162:163], v192 offset:9216
  v_mfma_f32_32x32x16_bf16 v[80:95], v[128:131], v[140:143], 0
  ds_read_b128 v[168:171], v196 offset:0
  ds_read_b128 v[172:175], v196 offset:4096
  v_mfma_f32_32x32x16_bf16 v[96:111], v[132:135], v[136:139], 0
  ds_read_b64_tr_b16 v[164:165], v193 offset:8192
  ds_read_b64_tr_b16 v[166:167], v193 offset:9216
  v_mfma_f32_32x32x16_bf16 v[112:127], v[132:135], v[140:143], 0
  s_waitcnt lgkmcnt(6)
  v_mfma_f32_32x32x16_bf16 v[64:79], v[144:147], v[152:155], v[64:79]
  ds_read_b64_tr_b16 v[128:129], v192 offset:12288
  ds_read_b64_tr_b16 v[130:131], v192 offset:13312
  v_mfma_f32_32x32x16_bf16 v[80:95], v[144:147], v[156:159], v[80:95]
  ds_read_b128 v[136:139], v197 offset:0
  ds_read_b128 v[140:143], v197 offset:4096
  v_mfma_f32_32x32x16_bf16 v[96:111], v[148:151], v[152:155], v[96:111]
  ds_read_b64_tr_b16 v[132:133], v193 offset:12288
  ds_read_b64_tr_b16 v[134:135], v193 offset:13312
  v_mfma_f32_32x32x16_bf16 v[112:127], v[148:151], v[156:159], v[112:127]
  s_waitcnt lgkmcnt(0)
  s_barrier
  v_mfma_f32_32x32x16_bf16 v[64:79], v[160:163], v[168:171], v[64:79]
  ds_read_b64_tr_b16 v[144:145], v192 offset:16384
  ds_read_b64_tr_b16 v[146:147], v192 offset:17408
  v_mfma_f32_32x32x16_bf16 v[80:95], v[160:163], v[172:175], v[80:95]
  ds_read_b128 v[152:155], v194 offset:16384
  ds_read_b128 v[156:159], v194 offset:20480
  v_mfma_f32_32x32x16_bf16 v[96:111], v[164:167], v[168:171], v[96:111]
  ds_read_b64_tr_b16 v[148:149], v193 offset:16384
  ds_read_b64_tr_b16 v[150:151], v193 offset:17408
  v_mfma_f32_32x32x16_bf16 v[112:127], v[164:167], v[172:175], v[112:127]
  v_mfma_f32_32x32x16_bf16 v[64:79], v[128:131], v[136:139], v[64:79]
  ds_read_b64_tr_b16 v[160:161], v192 offset:20480
  ds_read_b64_tr_b16 v[162:163], v192 offset:21504
  v_mfma_f32_32x32x16_bf16 v[80:95], v[128:131], v[140:143], v[80:95]
  ds_read_b128 v[168:171], v195 offset:16384
  ds_read_b128 v[172:175], v195 offset:20480
  v_mfma_f32_32x32x16_bf16 v[96:111], v[132:135], v[136:139], v[96:111]
  ds_read_b64_tr_b16 v[164:165], v193 offset:20480
  ds_read_b64_tr_b16 v[166:167], v193 offset:21504
  v_mfma_f32_32x32x16_bf16 v[112:127], v[132:135], v[140:143], v[112:127]
  s_waitcnt lgkmcnt(6)
  v_mfma_f32_32x32x16_bf16 v[64:79], v[144:147], v[152:155], v[64:79]
  ds_read_b64_tr_b16 v[128:129], v192 offset:24576
  ds_read_b64_tr_b16 v[130:131], v192 offset:25600
  v_mfma_f32_32x32x16_bf16 v[80:95], v[144:147], v[156:159], v[80:95]
  ds_read_b128 v[136:139], v196 offset:16384
  ds_read_b128 v[140:143], v196 offset:20480
  v_mfma_f32_32x32x16_bf16 v[96:111], v[148:151], v[152:155], v[96:111]
  ds_read_b64_tr_b16 v[132:133], v193 offset:24576
  ds_read_b64_tr_b16 v[134:135], v193 offset:25600
  v_mfma_f32_32x32x16_bf16 v[112:127], v[148:151], v[156:159], v[112:127]
  s_waitcnt lgkmcnt(6)
  v_mfma_f32_32x32x16_bf16 v[64:79], v[160:163], v[168:171], v[64:79]
  ds_read_b64_tr_b16 v[144:145], v192 offset:28672
  ds_read_b64_tr_b16 v[146:147], v192 offset:29696
  v_mfma_f32_32x32x16_bf16 v[80:95], v[160:163], v[172:175], v[80:95]
  ds_read_b128 v[152:155], v197 offset:16384
  ds_read_b128 v[156:159], v197 offset:20480
  v_mfma_f32_32x32x16_bf16 v[96:111], v[164:167], v[168:171], v[96:111]
  ds_read_b64_tr_b16 v[148:149], v193 offset:28672
  ds_read_b64_tr_b16 v[150:151], v193 offset:29696
  v_mfma_f32_32x32x16_bf16 v[112:127], v[164:167], v[172:175], v[112:127]
  s_waitcnt lgkmcnt(0)
  s_barrier
  v_mfma_f32_32x32x16_bf16 v[64:79], v[128:131], v[136:139], v[64:79]
  ds_read_b64_tr_b16 v[160:161], v192 offset:32768
  ds_read_b64_tr_b16 v[162:163], v192 offset:33792
  v_mfma_f32_32x32x16_bf16 v[80:95], v[128:131], v[140:143], v[80:95]
  ds_read_b128 v[168:171], v194 offset:32768
  ds_read_b128 v[172:175], v194 offset:36864
  v_mfma_f32_32x32x16_bf16 v[96:111], v[132:135], v[136:139], v[96:111]
  ds_read_b64_tr_b16 v[164:165], v193 offset:32768
  ds_read_b64_tr_b16 v[166:167], v193 offset:33792
  v_mfma_f32_32x32x16_bf16 v[112:127], v[132:135], v[140:143], v[112:127]
  v_mfma_f32_32x32x16_bf16 v[64:79], v[144:147], v[152:155], v[64:79]
  ds_read_b64_tr_b16 v[128:129], v192 offset:36864
  ds_read_b64_tr_b16 v[130:131], v192 offset:37888
  v_mfma_f32_32x32x16_bf16 v[80:95], v[144:147], v[156:159], v[80:95]
  ds_read_b128 v[136:139], v195 offset:32768
  ds_read_b128 v[140:143], v195 offset:36864
  v_mfma_f32_32x32x16_bf16 v[96:111], v[148:151], v[152:155], v[96:111]
  ds_read_b64_tr_b16 v[132:133], v193 offset:36864
  ds_read_b64_tr_b16 v[134:135], v193 offset:37888
  v_mfma_f32_32x32x16_bf16 v[112:127], v[148:151], v[156:159], v[112:127]
  s_waitcnt lgkmcnt(6)
  v_mfma_f32_32x32x16_bf16 v[64:79], v[160:163], v[168:171], v[64:79]
  ds_read_b64_tr_b16 v[144:145], v192 offset:40960
  ds_read_b64_tr_b16 v[146:147], v192 offset:41984
  v_mfma_f32_32x32x16_bf16 v[80:95], v[160:163], v[172:175], v[80:95]
  ds_read_b128 v[152:155], v196 offset:32768
  ds_read_b128 v[156:159], v196 offset:36864
  v_mfma_f32_32x32x16_bf16 v[96:111], v[164:167], v[168:171], v[96:111]
  ds_read_b64_tr_b16 v[148:149], v193 offset:40960
  ds_read_b64_tr_b16 v[150:151], v193 offset:41984
  v_mfma_f32_32x32x16_bf16 v[112:127], v[164:167], v[172:175], v[112:127]
  s_waitcnt lgkmcnt(6)
  v_mfma_f32_32x32x16_bf16 v[64:79], v[128:131], v[136:139], v[64:79]
  ds_read_b64_tr_b16 v[160:161], v192 offset:45056
  ds_read_b64_tr_b16 v[162:163], v192 offset:46080
  v_mfma_f32_32x32x16_bf16 v[80:95], v[128:131], v[140:143], v[80:95]
  ds_read_b128 v[168:171], v197 offset:32768
  ds_read_b128 v[172:175], v197 offset:36864
  v_mfma_f32_32x32x16_bf16 v[96:111], v[132:135], v[136:139], v[96:111]
  ds_read_b64_tr_b16 v[164:165], v193 offset:45056
  ds_read_b64_tr_b16 v[166:167], v193 offset:46080
  v_mfma_f32_32x32x16_bf16 v[112:127], v[132:135], v[140:143], v[112:127]
  s_waitcnt lgkmcnt(0)
  s_barrier
  v_mfma_f32_32x32x16_bf16 v[64:79], v[144:147], v[152:155], v[64:79]
  ds_read_b64_tr_b16 v[128:129], v192 offset:0
  ds_read_b64_tr_b16 v[130:131], v192 offset:1024
  v_mfma_f32_32x32x16_bf16 v[80:95], v[144:147], v[156:159], v[80:95]
  ds_read_b128 v[136:139], v194 offset:0
  ds_read_b128 v[140:143], v194 offset:4096
  v_mfma_f32_32x32x16_bf16 v[96:111], v[148:151], v[152:155], v[96:111]
  ds_read_b64_tr_b16 v[132:133], v193 offset:0
  ds_read_b64_tr_b16 v[134:135], v193 offset:1024
  v_mfma_f32_32x32x16_bf16 v[112:127], v[148:151], v[156:159], v[112:127]
  v_mfma_f32_32x32x16_bf16 v[64:79], v[160:163], v[168:171], v[64:79]
  ds_read_b64_tr_b16 v[144:145], v192 offset:4096
  ds_read_b64_tr_b16 v[146:147], v192 offset:5120
  v_mfma_f32_32x32x16_bf16 v[80:95], v[160:163], v[172:175], v[80:95]
  ds_read_b128 v[152:155], v195 offset:0
  ds_read_b128 v[156:159], v195 offset:4096
  v_mfma_f32_32x32x16_bf16 v[96:111], v[164:167], v[168:171], v[96:111]
  ds_read_b64_tr_b16 v[148:149], v193 offset:4096
  ds_read_b64_tr_b16 v[150:151], v193 offset:5120
  v_mfma_f32_32x32x16_bf16 v[112:127], v[164:167], v[172:175], v[112:127]
  s_waitcnt lgkmcnt(6)
  v_mfma_f32_32x32x16_bf16 v[64:79], v[128:131], v[136:139], v[64:79]
  ds_read_b64_tr_b16 v[160:161], v192 offset:8192
  ds_read_b64_tr_b16 v[162:163], v192 offset:9216
  v_mfma_f32_32x32x16_bf16 v[80:95], v[128:131], v[140:143], v[80:95]
  ds_read_b128 v[168:171], v196 offset:0
  ds_read_b128 v[172:175], v196 offset:4096
  v_mfma_f32_32x32x16_bf16 v[96:111], v[132:135], v[136:139], v[96:111]
  ds_read_b64_tr_b16 v[164:165], v193 offset:8192
  ds_read_b64_tr_b16 v[166:167], v193 offset:9216
  v_mfma_f32_32x32x16_bf16 v[112:127], v[132:135], v[140:143], v[112:127]
  s_waitcnt lgkmcnt(6)
  v_mfma_f32_32x32x16_bf16 v[64:79], v[144:147], v[152:155], v[64:79]
  ds_read_b64_tr_b16 v[128:129], v192 offset:12288
  ds_read_b64_tr_b16 v[130:131], v192 offset:13312
  v_mfma_f32_32x32x16_bf16 v[80:95], v[144:147], v[156:159], v[80:95]
  ds_read_b128 v[136:139], v197 offset:0
  ds_read_b128 v[140:143], v197 offset:4096
  v_mfma_f32_32x32x16_bf16 v[96:111], v[148:151], v[152:155], v[96:111]
  ds_read_b64_tr_b16 v[132:133], v193 offset:12288
  ds_read_b64_tr_b16 v[134:135], v193 offset:13312
  v_mfma_f32_32x32x16_bf16 v[112:127], v[148:151], v[156:159], v[112:127]
  s_waitcnt lgkmcnt(0)
  s_barrier
  v_mfma_f32_32x32x16_bf16 v[64:79], v[160:163], v[168:171], v[64:79]
  ds_read_b64_tr_b16 v[144:145], v192 offset:16384
  ds_read_b64_tr_b16 v[146:147], v192 offset:17408
  v_mfma_f32_32x32x16_bf16 v[80:95], v[160:163], v[172:175], v[80:95]
  ds_read_b128 v[152:155], v194 offset:16384
  ds_read_b128 v[156:159], v194 offset:20480
  v_mfma_f32_32x32x16_bf16 v[96:111], v[164:167], v[168:171], v[96:111]
  ds_read_b64_tr_b16 v[148:149], v193 offset:16384
  ds_read_b64_tr_b16 v[150:151], v193 offset:17408
  v_mfma_f32_32x32x16_bf16 v[112:127], v[164:167], v[172:175], v[112:127]
  v_mfma_f32_32x32x16_bf16 v[64:79], v[128:131], v[136:139], v[64:79]
  ds_read_b64_tr_b16 v[160:161], v192 offset:20480
  ds_read_b64_tr_b16 v[162:163], v192 offset:21504
  v_mfma_f32_32x32x16_bf16 v[80:95], v[128:131], v[140:143], v[80:95]
  ds_read_b128 v[168:171], v195 offset:16384
  ds_read_b128 v[172:175], v195 offset:20480
  v_mfma_f32_32x32x16_bf16 v[96:111], v[132:135], v[136:139], v[96:111]
  ds_read_b64_tr_b16 v[164:165], v193 offset:20480
  ds_read_b64_tr_b16 v[166:167], v193 offset:21504
  v_mfma_f32_32x32x16_bf16 v[112:127], v[132:135], v[140:143], v[112:127]
  s_waitcnt lgkmcnt(6)
  v_mfma_f32_32x32x16_bf16 v[64:79], v[144:147], v[152:155], v[64:79]
  ds_read_b64_tr_b16 v[128:129], v192 offset:24576
  ds_read_b64_tr_b16 v[130:131], v192 offset:25600
  v_mfma_f32_32x32x16_bf16 v[80:95], v[144:147], v[156:159], v[80:95]
  ds_read_b128 v[136:139], v196 offset:16384
  ds_read_b128 v[140:143], v196 offset:20480
  v_mfma_f32_32x32x16_bf16 v[96:111], v[148:151], v[152:155], v[96:111]
  ds_read_b64_tr_b16 v[132:133], v193 offset:24576
  ds_read_b64_tr_b16 v[134:135], v193 offset:25600
  v_mfma_f32_32x32x16_bf16 v[112:127], v[148:151], v[156:159], v[112:127]
  s_waitcnt lgkmcnt(6)
  v_mfma_f32_32x32x16_bf16 v[64:79], v[160:163], v[168:171], v[64:79]
  ds_read_b64_tr_b16 v[144:145], v192 offset:28672
  ds_read_b64_tr_b16 v[146:147], v192 offset:29696
  v_mfma_f32_32x32x16_bf16 v[80:95], v[160:163], v[172:175], v[80:95]
  ds_read_b128 v[152:155], v197 offset:16384
  ds_read_b128 v[156:159], v197 offset:20480
  v_mfma_f32_32x32x16_bf16 v[96:111], v[164:167], v[168:171], v[96:111]
  ds_read_b64_tr_b16 v[148:149], v193 offset:28672
  ds_read_b64_tr_b16 v[150:151], v193 offset:29696
  v_mfma_f32_32x32x16_bf16 v[112:127], v[164:167], v[172:175], v[112:127]
  s_waitcnt lgkmcnt(0)
  s_barrier
  v_mfma_f32_32x32x16_bf16 v[64:79], v[128:131], v[136:139], v[64:79]
  ds_read_b64_tr_b16 v[160:161], v192 offset:32768
  ds_read_b64_tr_b16 v[162:163], v192 offset:33792
  v_mfma_f32_32x32x16_bf16 v[80:95], v[128:131], v[140:143], v[80:95]
  ds_read_b128 v[168:171], v194 offset:32768
  ds_read_b128 v[172:175], v194 offset:36864
  v_mfma_f32_32x32x16_bf16 v[96:111], v[132:135], v[136:139], v[96:111]
  ds_read_b64_tr_b16 v[164:165], v193 offset:32768
  ds_read_b64_tr_b16 v[166:167], v193 offset:33792
  v_mfma_f32_32x32x16_bf16 v[112:127], v[132:135], v[140:143], v[112:127]
  v_mfma_f32_32x32x16_bf16 v[64:79], v[144:147], v[152:155], v[64:79]
  ds_read_b64_tr_b16 v[128:129], v192 offset:36864
  ds_read_b64_tr_b16 v[130:131], v192 offset:37888
  v_mfma_f32_32x32x16_bf16 v[80:95], v[144:147], v[156:159], v[80:95]
  ds_read_b128 v[136:139], v195 offset:32768
  ds_read_b128 v[140:143], v195 offset:36864
  v_mfma_f32_32x32x16_bf16 v[96:111], v[148:151], v[152:155], v[96:111]
  ds_read_b64_tr_b16 v[132:133], v193 offset:36864
  ds_read_b64_tr_b16 v[134:135], v193 offset:37888
  v_mfma_f32_32x32x16_bf16 v[112:127], v[148:151], v[156:159], v[112:127]
  s_waitcnt lgkmcnt(6)
  v_mfma_f32_32x32x16_bf16 v[64:79], v[160:163], v[168:171], v[64:79]
  ds_read_b64_tr_b16 v[144:145], v192 offset:40960
  ds_read_b64_tr_b16 v[146:147], v192 offset:41984
  v_mfma_f32_32x32x16_bf16 v[80:95], v[160:163], v[172:175], v[80:95]
  ds_read_b128 v[152:155], v196 offset:32768
  ds_read_b128 v[156:159], v196 offset:36864
  v_mfma_f32_32x32x16_bf16 v[96:111], v[164:167], v[168:171], v[96:111]
  ds_read_b64_tr_b16 v[148:149], v193 offset:40960
  ds_read_b64_tr_b16 v[150:151], v193 offset:41984
  v_mfma_f32_32x32x16_bf16 v[112:127], v[164:167], v[172:175], v[112:127]
  s_waitcnt lgkmcnt(6)
  v_mfma_f32_32x32x16_bf16 v[64:79], v[128:131], v[136:139], v[64:79]
  ds_read_b64_tr_b16 v[160:161], v192 offset:45056
  ds_read_b64_tr_b16 v[162:163], v192 offset:46080
  v_mfma_f32_32x32x16_bf16 v[80:95], v[128:131], v[140:143], v[80:95]
  ds_read_b128 v[168:171], v197 offset:32768
  ds_read_b128 v[172:175], v197 offset:36864
  v_mfma_f32_32x32x16_bf16 v[96:111], v[132:135], v[136:139], v[96:111]
  ds_read_b64_tr_b16 v[164:165], v193 offset:45056
  ds_read_b64_tr_b16 v[166:167], v193 offset:46080
  v_mfma_f32_32x32x16_bf16 v[112:127], v[132:135], v[140:143], v[112:127]
  s_waitcnt lgkmcnt(0)
  s_barrier
  v_mfma_f32_32x32x16_bf16 v[64:79], v[144:147], v[152:155], v[64:79]
  ds_read_b64_tr_b16 v[128:129], v192 offset:0
  ds_read_b64_tr_b16 v[130:131], v192 offset:1024
  v_mfma_f32_32x32x16_bf16 v[80:95], v[144:147], v[156:159], v[80:95]
  ds_read_b128 v[136:139], v194 offset:0
  ds_read_b128 v[140:143], v194 offset:4096
  v_mfma_f32_32x32x16_bf16 v[96:111], v[148:151], v[152:155], v[96:111]
  ds_read_b64_tr_b16 v[132:133], v193 offset:0
  ds_read_b64_tr_b16 v[134:135], v193 offset:1024
  v_mfma_f32_32x32x16_bf16 v[112:127], v[148:151], v[156:159], v[112:127]
  v_mfma_f32_32x32x16_bf16 v[64:79], v[160:163], v[168:171], v[64:79]
  ds_read_b64_tr_b16 v[144:145], v192 offset:4096
  ds_read_b64_tr_b16 v[146:147], v192 offset:5120
  v_mfma_f32_32x32x16_bf16 v[80:95], v[160:163], v[172:175], v[80:95]
  ds_read_b128 v[152:155], v195 offset:0
  ds_read_b128 v[156:159], v195 offset:4096
  v_mfma_f32_32x32x16_bf16 v[96:111], v[164:167], v[168:171], v[96:111]
  ds_read_b64_tr_b16 v[148:149], v193 offset:4096
  ds_read_b64_tr_b16 v[150:151], v193 offset:5120
  v_mfma_f32_32x32x16_bf16 v[112:127], v[164:167], v[172:175], v[112:127]
  s_waitcnt lgkmcnt(6)
  v_mfma_f32_32x32x16_bf16 v[64:79], v[128:131], v[136:139], v[64:79]
  ds_read_b64_tr_b16 v[160:161], v192 offset:8192
  ds_read_b64_tr_b16 v[162:163], v192 offset:9216
  v_mfma_f32_32x32x16_bf16 v[80:95], v[128:131], v[140:143], v[80:95]
  ds_read_b128 v[168:171], v196 offset:0
  ds_read_b128 v[172:175], v196 offset:4096
  v_mfma_f32_32x32x16_bf16 v[96:111], v[132:135], v[136:139], v[96:111]
  ds_read_b64_tr_b16 v[164:165], v193 offset:8192
  ds_read_b64_tr_b16 v[166:167], v193 offset:9216
  v_mfma_f32_32x32x16_bf16 v[112:127], v[132:135], v[140:143], v[112:127]
  s_waitcnt lgkmcnt(6)
  v_mfma_f32_32x32x16_bf16 v[64:79], v[144:147], v[152:155], v[64:79]
  ds_read_b64_tr_b16 v[128:129], v192 offset:12288
  ds_read_b64_tr_b16 v[130:131], v192 offset:13312
  v_mfma_f32_32x32x16_bf16 v[80:95], v[144:147], v[156:159], v[80:95]
  ds_read_b128 v[136:139], v197 offset:0
  ds_read_b128 v[140:143], v197 offset:4096
  v_mfma_f32_32x32x16_bf16 v[96:111], v[148:151], v[152:155], v[96:111]
  ds_read_b64_tr_b16 v[132:133], v193 offset:12288
  ds_read_b64_tr_b16 v[134:135], v193 offset:13312
  v_mfma_f32_32x32x16_bf16 v[112:127], v[148:151], v[156:159], v[112:127]
  s_waitcnt lgkmcnt(0)
  s_barrier
  v_mfma_f32_32x32x16_bf16 v[64:79], v[160:163], v[168:171], v[64:79]
  ds_read_b64_tr_b16 v[144:145], v192 offset:16384
  ds_read_b64_tr_b16 v[146:147], v192 offset:17408
  v_mfma_f32_32x32x16_bf16 v[80:95], v[160:163], v[172:175], v[80:95]
  ds_read_b128 v[152:155], v194 offset:16384
  ds_read_b128 v[156:159], v194 offset:20480
  v_mfma_f32_32x32x16_bf16 v[96:111], v[164:167], v[168:171], v[96:111]
  ds_read_b64_tr_b16 v[148:149], v193 offset:16384
  ds_read_b64_tr_b16 v[150:151], v193 offset:17408
  v_mfma_f32_32x32x16_bf16 v[112:127], v[164:167], v[172:175], v[112:127]
  v_mfma_f32_32x32x16_bf16 v[64:79], v[128:131], v[136:139], v[64:79]
  ds_read_b64_tr_b16 v[160:161], v192 offset:20480
  ds_read_b64_tr_b16 v[162:163], v192 offset:21504
  v_mfma_f32_32x32x16_bf16 v[80:95], v[128:131], v[140:143], v[80:95]
  ds_read_b128 v[168:171], v195 offset:16384
  ds_read_b128 v[172:175], v195 offset:20480
  v_mfma_f32_32x32x16_bf16 v[96:111], v[132:135], v[136:139], v[96:111]
  ds_read_b64_tr_b16 v[164:165], v193 offset:20480
  ds_read_b64_tr_b16 v[166:167], v193 offset:21504
  v_mfma_f32_32x32x16_bf16 v[112:127], v[132:135], v[140:143], v[112:127]
  s_waitcnt lgkmcnt(6)
  v_mfma_f32_32x32x16_bf16 v[64:79], v[144:147], v[152:155], v[64:79]
  ds_read_b64_tr_b16 v[128:129], v192 offset:24576
  ds_read_b64_tr_b16 v[130:131], v192 offset:25600
  v_mfma_f32_32x32x16_bf16 v[80:95], v[144:147], v[156:159], v[80:95]
  ds_read_b128 v[136:139], v196 offset:16384
  ds_read_b128 v[140:143], v196 offset:20480
  v_mfma_f32_32x32x16_bf16 v[96:111], v[148:151], v[152:155], v[96:111]
  ds_read_b64_tr_b16 v[132:133], v193 offset:24576
  ds_read_b64_tr_b16 v[134:135], v193 offset:25600
  v_mfma_f32_32x32x16_bf16 v[112:127], v[148:151], v[156:159], v[112:127]
  s_waitcnt lgkmcnt(6)
  v_mfma_f32_32x32x16_bf16 v[64:79], v[160:163], v[168:171], v[64:79]
  ds_read_b64_tr_b16 v[144:145], v192 offset:28672
  ds_read_b64_tr_b16 v[146:147], v192 offset:29696
  v_mfma_f32_32x32x16_bf16 v[80:95], v[160:163], v[172:175], v[80:95]
  ds_read_b128 v[152:155], v197 offset:16384
  ds_read_b128 v[156:159], v197 offset:20480
  v_mfma_f32_32x32x16_bf16 v[96:111], v[164:167], v[168:171], v[96:111]
  ds_read_b64_tr_b16 v[148:149], v193 offset:28672
  ds_read_b64_tr_b16 v[150:151], v193 offset:29696
  v_mfma_f32_32x32x16_bf16 v[112:127], v[164:167], v[172:175], v[112:127]
  s_waitcnt lgkmcnt(0)
  s_barrier
  v_mfma_f32_32x32x16_bf16 v[64:79], v[128:131], v[136:139], v[64:79]
  ds_read_b64_tr_b16 v[160:161], v192 offset:32768
  ds_read_b64_tr_b16 v[162:163], v192 offset:33792
  v_mfma_f32_32x32x16_bf16 v[80:95], v[128:131], v[140:143], v[80:95]
  ds_read_b128 v[168:171], v194 offset:32768
  ds_read_b128 v[172:175], v194 offset:36864
  v_mfma_f32_32x32x16_bf16 v[96:111], v[132:135], v[136:139], v[96:111]
  ds_read_b64_tr_b16 v[164:165], v193 offset:32768
  ds_read_b64_tr_b16 v[166:167], v193 offset:33792
  v_mfma_f32_32x32x16_bf16 v[112:127], v[132:135], v[140:143], v[112:127]
  v_mfma_f32_32x32x16_bf16 v[64:79], v[144:147], v[152:155], v[64:79]
  ds_read_b64_tr_b16 v[128:129], v192 offset:36864
  ds_read_b64_tr_b16 v[130:131], v192 offset:37888
  v_mfma_f32_32x32x16_bf16 v[80:95], v[144:147], v[156:159], v[80:95]
  ds_read_b128 v[136:139], v195 offset:32768
  ds_read_b128 v[140:143], v195 offset:36864
  v_mfma_f32_32x32x16_bf16 v[96:111], v[148:151], v[152:155], v[96:111]
  ds_read_b64_tr_b16 v[132:133], v193 offset:36864
  ds_read_b64_tr_b16 v[134:135], v193 offset:37888
  v_mfma_f32_32x32x16_bf16 v[112:127], v[148:151], v[156:159], v[112:127]
  s_waitcnt lgkmcnt(6)
  v_mfma_f32_32x32x16_bf16 v[64:79], v[160:163], v[168:171], v[64:79]
  ds_read_b64_tr_b16 v[144:145], v192 offset:40960
  ds_read_b64_tr_b16 v[146:147], v192 offset:41984
  v_mfma_f32_32x32x16_bf16 v[80:95], v[160:163], v[172:175], v[80:95]
  ds_read_b128 v[152:155], v196 offset:32768
  ds_read_b128 v[156:159], v196 offset:36864
  v_mfma_f32_32x32x16_bf16 v[96:111], v[164:167], v[168:171], v[96:111]
  ds_read_b64_tr_b16 v[148:149], v193 offset:40960
  ds_read_b64_tr_b16 v[150:151], v193 offset:41984
  v_mfma_f32_32x32x16_bf16 v[112:127], v[164:167], v[172:175], v[112:127]
  s_waitcnt lgkmcnt(6)
  v_mfma_f32_32x32x16_bf16 v[64:79], v[128:131], v[136:139], v[64:79]
  ds_read_b64_tr_b16 v[160:161], v192 offset:45056
  ds_read_b64_tr_b16 v[162:163], v192 offset:46080
  v_mfma_f32_32x32x16_bf16 v[80:95], v[128:131], v[140:143], v[80:95]
  ds_read_b128 v[168:171], v197 offset:32768
  ds_read_b128 v[172:175], v197 offset:36864
  v_mfma_f32_32x32x16_bf16 v[96:111], v[132:135], v[136:139], v[96:111]
  ds_read_b64_tr_b16 v[164:165], v193 offset:45056
  ds_read_b64_tr_b16 v[166:167], v193 offset:46080
  v_mfma_f32_32x32x16_bf16 v[112:127], v[132:135], v[140:143], v[112:127]
  s_waitcnt lgkmcnt(0)
  s_barrier
  v_mfma_f32_32x32x16_bf16 v[64:79], v[144:147], v[152:155], v[64:79]
  ds_read_b64_tr_b16 v[128:129], v192 offset:0
  ds_read_b64_tr_b16 v[130:131], v192 offset:1024
  v_mfma_f32_32x32x16_bf16 v[80:95], v[144:147], v[156:159], v[80:95]
  ds_read_b128 v[136:139], v194 offset:0
  ds_read_b128 v[140:143], v194 offset:4096
  v_mfma_f32_32x32x16_bf16 v[96:111], v[148:151], v[152:155], v[96:111]
  ds_read_b64_tr_b16 v[132:133], v193 offset:0
  ds_read_b64_tr_b16 v[134:135], v193 offset:1024
  v_mfma_f32_32x32x16_bf16 v[112:127], v[148:151], v[156:159], v[112:127]
  v_mfma_f32_32x32x16_bf16 v[64:79], v[160:163], v[168:171], v[64:79]
  ds_read_b64_tr_b16 v[144:145], v192 offset:4096
  ds_read_b64_tr_b16 v[146:147], v192 offset:5120
  v_mfma_f32_32x32x16_bf16 v[80:95], v[160:163], v[172:175], v[80:95]
  ds_read_b128 v[152:155], v195 offset:0
  ds_read_b128 v[156:159], v195 offset:4096
  v_mfma_f32_32x32x16_bf16 v[96:111], v[164:167], v[168:171], v[96:111]
  ds_read_b64_tr_b16 v[148:149], v193 offset:4096
  ds_read_b64_tr_b16 v[150:151], v193 offset:5120
  v_mfma_f32_32x32x16_bf16 v[112:127], v[164:167], v[172:175], v[112:127]
  s_waitcnt lgkmcnt(6)
  v_mfma_f32_32x32x16_bf16 v[64:79], v[128:131], v[136:139], v[64:79]
  ds_read_b64_tr_b16 v[160:161], v192 offset:8192
  ds_read_b64_tr_b16 v[162:163], v192 offset:9216
  v_mfma_f32_32x32x16_bf16 v[80:95], v[128:131], v[140:143], v[80:95]
  ds_read_b128 v[168:171], v196 offset:0
  ds_read_b128 v[172:175], v196 offset:4096
  v_mfma_f32_32x32x16_bf16 v[96:111], v[132:135], v[136:139], v[96:111]
  ds_read_b64_tr_b16 v[164:165], v193 offset:8192
  ds_read_b64_tr_b16 v[166:167], v193 offset:9216
  v_mfma_f32_32x32x16_bf16 v[112:127], v[132:135], v[140:143], v[112:127]
  s_waitcnt lgkmcnt(6)
  v_mfma_f32_32x32x16_bf16 v[64:79], v[144:147], v[152:155], v[64:79]
  ds_read_b64_tr_b16 v[128:129], v192 offset:12288
  ds_read_b64_tr_b16 v[130:131], v192 offset:13312
  v_mfma_f32_32x32x16_bf16 v[80:95], v[144:147], v[156:159], v[80:95]
  ds_read_b128 v[136:139], v197 offset:0
  ds_read_b128 v[140:143], v197 offset:4096
  v_mfma_f32_32x32x16_bf16 v[96:111], v[148:151], v[152:155], v[96:111]
  ds_read_b64_tr_b16 v[132:133], v193 offset:12288
  ds_read_b64_tr_b16 v[134:135], v193 offset:13312
  v_mfma_f32_32x32x16_bf16 v[112:127], v[148:151], v[156:159], v[112:127]
  s_waitcnt lgkmcnt(0)
  s_barrier
  v_mfma_f32_32x32x16_bf16 v[64:79], v[160:163], v[168:171], v[64:79]
  ds_read_b64_tr_b16 v[144:145], v192 offset:16384
  ds_read_b64_tr_b16 v[146:147], v192 offset:17408
  v_mfma_f32_32x32x16_bf16 v[80:95], v[160:163], v[172:175], v[80:95]
  ds_read_b128 v[152:155], v194 offset:16384
  ds_read_b128 v[156:159], v194 offset:20480
  v_mfma_f32_32x32x16_bf16 v[96:111], v[164:167], v[168:171], v[96:111]
  ds_read_b64_tr_b16 v[148:149], v193 offset:16384
  ds_read_b64_tr_b16 v[150:151], v193 offset:17408
  v_mfma_f32_32x32x16_bf16 v[112:127], v[164:167], v[172:175], v[112:127]
  v_mfma_f32_32x32x16_bf16 v[64:79], v[128:131], v[136:139], v[64:79]
  ds_read_b64_tr_b16 v[160:161], v192 offset:20480
  ds_read_b64_tr_b16 v[162:163], v192 offset:21504
  v_mfma_f32_32x32x16_bf16 v[80:95], v[128:131], v[140:143], v[80:95]
  ds_read_b128 v[168:171], v195 offset:16384
  ds_read_b128 v[172:175], v195 offset:20480
  v_mfma_f32_32x32x16_bf16 v[96:111], v[132:135], v[136:139], v[96:111]
  ds_read_b64_tr_b16 v[164:165], v193 offset:20480
  ds_read_b64_tr_b16 v[166:167], v193 offset:21504
  v_mfma_f32_32x32x16_bf16 v[112:127], v[132:135], v[140:143], v[112:127]
  s_waitcnt lgkmcnt(6)
  v_mfma_f32_32x32x16_bf16 v[64:79], v[144:147], v[152:155], v[64:79]
  ds_read_b64_tr_b16 v[128:129], v192 offset:24576
  ds_read_b64_tr_b16 v[130:131], v192 offset:25600
  v_mfma_f32_32x32x16_bf16 v[80:95], v[144:147], v[156:159], v[80:95]
  ds_read_b128 v[136:139], v196 offset:16384
  ds_read_b128 v[140:143], v196 offset:20480
  v_mfma_f32_32x32x16_bf16 v[96:111], v[148:151], v[152:155], v[96:111]
  ds_read_b64_tr_b16 v[132:133], v193 offset:24576
  ds_read_b64_tr_b16 v[134:135], v193 offset:25600
  v_mfma_f32_32x32x16_bf16 v[112:127], v[148:151], v[156:159], v[112:127]
  s_waitcnt lgkmcnt(6)
  v_mfma_f32_32x32x16_bf16 v[64:79], v[160:163], v[168:171], v[64:79]
  ds_read_b64_tr_b16 v[144:145], v192 offset:28672
  ds_read_b64_tr_b16 v[146:147], v192 offset:29696
  v_mfma_f32_32x32x16_bf16 v[80:95], v[160:163], v[172:175], v[80:95]
  ds_read_b128 v[152:155], v197 offset:16384
  ds_read_b128 v[156:159], v197 offset:20480
  v_mfma_f32_32x32x16_bf16 v[96:111], v[164:167], v[168:171], v[96:111]
  ds_read_b64_tr_b16 v[148:149], v193 offset:28672
  ds_read_b64_tr_b16 v[150:151], v193 offset:29696
  v_mfma_f32_32x32x16_bf16 v[112:127], v[164:167], v[172:175], v[112:127]
  s_waitcnt lgkmcnt(0)
  s_barrier
  v_mfma_f32_32x32x16_bf16 v[64:79], v[128:131], v[136:139], v[64:79]
  ds_read_b64_tr_b16 v[160:161], v192 offset:32768
  ds_read_b64_tr_b16 v[162:163], v192 offset:33792
  v_mfma_f32_32x32x16_bf16 v[80:95], v[128:131], v[140:143], v[80:95]
  ds_read_b128 v[168:171], v194 offset:32768
  ds_read_b128 v[172:175], v194 offset:36864
  v_mfma_f32_32x32x16_bf16 v[96:111], v[132:135], v[136:139], v[96:111]
  ds_read_b64_tr_b16 v[164:165], v193 offset:32768
  ds_read_b64_tr_b16 v[166:167], v193 offset:33792
  v_mfma_f32_32x32x16_bf16 v[112:127], v[132:135], v[140:143], v[112:127]
  v_mfma_f32_32x32x16_bf16 v[64:79], v[144:147], v[152:155], v[64:79]
  ds_read_b64_tr_b16 v[128:129], v192 offset:36864
  ds_read_b64_tr_b16 v[130:131], v192 offset:37888
  v_mfma_f32_32x32x16_bf16 v[80:95], v[144:147], v[156:159], v[80:95]
  ds_read_b128 v[136:139], v195 offset:32768
  ds_read_b128 v[140:143], v195 offset:36864
  v_mfma_f32_32x32x16_bf16 v[96:111], v[148:151], v[152:155], v[96:111]
  ds_read_b64_tr_b16 v[132:133], v193 offset:36864
  ds_read_b64_tr_b16 v[134:135], v193 offset:37888
  v_mfma_f32_32x32x16_bf16 v[112:127], v[148:151], v[156:159], v[112:127]
  s_waitcnt lgkmcnt(6)
  v_mfma_f32_32x32x16_bf16 v[64:79], v[160:163], v[168:171], v[64:79]
  ds_read_b64_tr_b16 v[144:145], v192 offset:40960
  ds_read_b64_tr_b16 v[146:147], v192 offset:41984
  v_mfma_f32_32x32x16_bf16 v[80:95], v[160:163], v[172:175], v[80:95]
  ds_read_b128 v[152:155], v196 offset:32768
  ds_read_b128 v[156:159], v196 offset:36864
  v_mfma_f32_32x32x16_bf16 v[96:111], v[164:167], v[168:171], v[96:111]
  ds_read_b64_tr_b16 v[148:149], v193 offset:40960
  ds_read_b64_tr_b16 v[150:151], v193 offset:41984
  v_mfma_f32_32x32x16_bf16 v[112:127], v[164:167], v[172:175], v[112:127]
  s_waitcnt lgkmcnt(6)
  v_mfma_f32_32x32x16_bf16 v[64:79], v[128:131], v[136:139], v[64:79]
  ds_read_b64_tr_b16 v[160:161], v192 offset:45056
  ds_read_b64_tr_b16 v[162:163], v192 offset:46080
  v_mfma_f32_32x32x16_bf16 v[80:95], v[128:131], v[140:143], v[80:95]
  ds_read_b128 v[168:171], v197 offset:32768
  ds_read_b128 v[172:175], v197 offset:36864
  v_mfma_f32_32x32x16_bf16 v[96:111], v[132:135], v[136:139], v[96:111]
  ds_read_b64_tr_b16 v[164:165], v193 offset:45056
  ds_read_b64_tr_b16 v[166:167], v193 offset:46080
  v_mfma_f32_32x32x16_bf16 v[112:127], v[132:135], v[140:143], v[112:127]
  s_waitcnt lgkmcnt(0)
  s_barrier
  v_mfma_f32_32x32x16_bf16 v[64:79], v[144:147], v[152:155], v[64:79]
  ds_read_b64_tr_b16 v[128:129], v192 offset:0
  ds_read_b64_tr_b16 v[130:131], v192 offset:1024
  v_mfma_f32_32x32x16_bf16 v[80:95], v[144:147], v[156:159], v[80:95]
  ds_read_b128 v[136:139], v194 offset:0
  ds_read_b128 v[140:143], v194 offset:4096
  v_mfma_f32_32x32x16_bf16 v[96:111], v[148:151], v[152:155], v[96:111]
  ds_read_b64_tr_b16 v[132:133], v193 offset:0
  ds_read_b64_tr_b16 v[134:135], v193 offset:1024
  v_mfma_f32_32x32x16_bf16 v[112:127], v[148:151], v[156:159], v[112:127]
  v_mfma_f32_32x32x16_bf16 v[64:79], v[160:163], v[168:171], v[64:79]
  ds_read_b64_tr_b16 v[144:145], v192 offset:4096
  ds_read_b64_tr_b16 v[146:147], v192 offset:5120
  v_mfma_f32_32x32x16_bf16 v[80:95], v[160:163], v[172:175], v[80:95]
  ds_read_b128 v[152:155], v195 offset:0
  ds_read_b128 v[156:159], v195 offset:4096
  v_mfma_f32_32x32x16_bf16 v[96:111], v[164:167], v[168:171], v[96:111]
  ds_read_b64_tr_b16 v[148:149], v193 offset:4096
  ds_read_b64_tr_b16 v[150:151], v193 offset:5120
  v_mfma_f32_32x32x16_bf16 v[112:127], v[164:167], v[172:175], v[112:127]
  s_waitcnt lgkmcnt(6)
  v_mfma_f32_32x32x16_bf16 v[64:79], v[128:131], v[136:139], v[64:79]
  ds_read_b64_tr_b16 v[160:161], v192 offset:8192
  ds_read_b64_tr_b16 v[162:163], v192 offset:9216
  v_mfma_f32_32x32x16_bf16 v[80:95], v[128:131], v[140:143], v[80:95]
  ds_read_b128 v[168:171], v196 offset:0
  ds_read_b128 v[172:175], v196 offset:4096
  v_mfma_f32_32x32x16_bf16 v[96:111], v[132:135], v[136:139], v[96:111]
  ds_read_b64_tr_b16 v[164:165], v193 offset:8192
  ds_read_b64_tr_b16 v[166:167], v193 offset:9216
  v_mfma_f32_32x32x16_bf16 v[112:127], v[132:135], v[140:143], v[112:127]
  s_waitcnt lgkmcnt(6)
  v_mfma_f32_32x32x16_bf16 v[64:79], v[144:147], v[152:155], v[64:79]
  ds_read_b64_tr_b16 v[128:129], v192 offset:12288
  ds_read_b64_tr_b16 v[130:131], v192 offset:13312
  v_mfma_f32_32x32x16_bf16 v[80:95], v[144:147], v[156:159], v[80:95]
  ds_read_b128 v[136:139], v197 offset:0
  ds_read_b128 v[140:143], v197 offset:4096
  v_mfma_f32_32x32x16_bf16 v[96:111], v[148:151], v[152:155], v[96:111]
  ds_read_b64_tr_b16 v[132:133], v193 offset:12288
  ds_read_b64_tr_b16 v[134:135], v193 offset:13312
  v_mfma_f32_32x32x16_bf16 v[112:127], v[148:151], v[156:159], v[112:127]
  s_waitcnt lgkmcnt(0)
  s_barrier
  v_mfma_f32_32x32x16_bf16 v[64:79], v[160:163], v[168:171], v[64:79]
  ds_read_b64_tr_b16 v[144:145], v192 offset:16384
  ds_read_b64_tr_b16 v[146:147], v192 offset:17408
  v_mfma_f32_32x32x16_bf16 v[80:95], v[160:163], v[172:175], v[80:95]
  ds_read_b128 v[152:155], v194 offset:16384
  ds_read_b128 v[156:159], v194 offset:20480
  v_mfma_f32_32x32x16_bf16 v[96:111], v[164:167], v[168:171], v[96:111]
  ds_read_b64_tr_b16 v[148:149], v193 offset:16384
  ds_read_b64_tr_b16 v[150:151], v193 offset:17408
  v_mfma_f32_32x32x16_bf16 v[112:127], v[164:167], v[172:175], v[112:127]
  v_mfma_f32_32x32x16_bf16 v[64:79], v[128:131], v[136:139], v[64:79]
  ds_read_b64_tr_b16 v[160:161], v192 offset:20480
  ds_read_b64_tr_b16 v[162:163], v192 offset:21504
  v_mfma_f32_32x32x16_bf16 v[80:95], v[128:131], v[140:143], v[80:95]
  ds_read_b128 v[168:171], v195 offset:16384
  ds_read_b128 v[172:175], v195 offset:20480
  v_mfma_f32_32x32x16_bf16 v[96:111], v[132:135], v[136:139], v[96:111]
  ds_read_b64_tr_b16 v[164:165], v193 offset:20480
  ds_read_b64_tr_b16 v[166:167], v193 offset:21504
  v_mfma_f32_32x32x16_bf16 v[112:127], v[132:135], v[140:143], v[112:127]
  s_waitcnt lgkmcnt(6)
  v_mfma_f32_32x32x16_bf16 v[64:79], v[144:147], v[152:155], v[64:79]
  ds_read_b64_tr_b16 v[128:129], v192 offset:24576
  ds_read_b64_tr_b16 v[130:131], v192 offset:25600
  v_mfma_f32_32x32x16_bf16 v[80:95], v[144:147], v[156:159], v[80:95]
  ds_read_b128 v[136:139], v196 offset:16384
  ds_read_b128 v[140:143], v196 offset:20480
  v_mfma_f32_32x32x16_bf16 v[96:111], v[148:151], v[152:155], v[96:111]
  ds_read_b64_tr_b16 v[132:133], v193 offset:24576
  ds_read_b64_tr_b16 v[134:135], v193 offset:25600
  v_mfma_f32_32x32x16_bf16 v[112:127], v[148:151], v[156:159], v[112:127]
  s_waitcnt lgkmcnt(6)
  v_mfma_f32_32x32x16_bf16 v[64:79], v[160:163], v[168:171], v[64:79]
  ds_read_b64_tr_b16 v[144:145], v192 offset:28672
  ds_read_b64_tr_b16 v[146:147], v192 offset:29696
  v_mfma_f32_32x32x16_bf16 v[80:95], v[160:163], v[172:175], v[80:95]
  ds_read_b128 v[152:155], v197 offset:16384
  ds_read_b128 v[156:159], v197 offset:20480
  v_mfma_f32_32x32x16_bf16 v[96:111], v[164:167], v[168:171], v[96:111]
  ds_read_b64_tr_b16 v[148:149], v193 offset:28672
  ds_read_b64_tr_b16 v[150:151], v193 offset:29696
  v_mfma_f32_32x32x16_bf16 v[112:127], v[164:167], v[172:175], v[112:127]
  s_waitcnt lgkmcnt(0)
  s_barrier
  v_mfma_f32_32x32x16_bf16 v[64:79], v[128:131], v[136:139], v[64:79]
  ds_read_b64_tr_b16 v[160:161], v192 offset:32768
  ds_read_b64_tr_b16 v[162:163], v192 offset:33792
  v_mfma_f32_32x32x16_bf16 v[80:95], v[128:131], v[140:143], v[80:95]
  ds_read_b128 v[168:171], v194 offset:32768
  ds_read_b128 v[172:175], v194 offset:36864
  v_mfma_f32_32x32x16_bf16 v[96:111], v[132:135], v[136:139], v[96:111]
  ds_read_b64_tr_b16 v[164:165], v193 offset:32768
  ds_read_b64_tr_b16 v[166:167], v193 offset:33792
  v_mfma_f32_32x32x16_bf16 v[112:127], v[132:135], v[140:143], v[112:127]
  s_add_u32 m0, s61, 98304
  s_add_u32 s58, s75, 0
  s_and_b32 s58, s58, 7
  s_lshl_b32 s58, s58, 14
  s_add_u32 s58, s58, s61
  buffer_load_dwordx4 v28, s[36:39], s58 offen offset:0 nt lds
  buffer_load_dwordx4 v29, s[36:39], s58 offen offset:1024 nt lds
  buffer_load_dwordx4 v30, s[36:39], s58 offen offset:2048 nt lds
  buffer_load_dwordx4 v31, s[36:39], s58 offen offset:3072 nt lds
  v_mfma_f32_32x32x16_bf16 v[64:79], v[144:147], v[152:155], v[64:79]
  ds_read_b64_tr_b16 v[128:129], v192 offset:36864
  ds_read_b64_tr_b16 v[130:131], v192 offset:37888
  v_mfma_f32_32x32x16_bf16 v[80:95], v[144:147], v[156:159], v[80:95]
  ds_read_b128 v[136:139], v195 offset:32768
  ds_read_b128 v[140:143], v195 offset:36864
  v_mfma_f32_32x32x16_bf16 v[96:111], v[148:151], v[152:155], v[96:111]
  ds_read_b64_tr_b16 v[132:133], v193 offset:36864
  ds_read_b64_tr_b16 v[134:135], v193 offset:37888
  v_mfma_f32_32x32x16_bf16 v[112:127], v[148:151], v[156:159], v[112:127]
  s_add_u32 m0, s61, 114688
  s_add_u32 s58, s75, 1
  s_and_b32 s58, s58, 7
  s_lshl_b32 s58, s58, 14
  s_add_u32 s58, s58, s61
  buffer_load_dwordx4 v28, s[36:39], s58 offen offset:0 nt lds
  buffer_load_dwordx4 v29, s[36:39], s58 offen offset:1024 nt lds
  buffer_load_dwordx4 v30, s[36:39], s58 offen offset:2048 nt lds
  buffer_load_dwordx4 v31, s[36:39], s58 offen offset:3072 nt lds
  s_waitcnt lgkmcnt(6)
  v_mfma_f32_32x32x16_bf16 v[64:79], v[160:163], v[168:171], v[64:79]
  ds_read_b64_tr_b16 v[144:145], v192 offset:40960
  ds_read_b64_tr_b16 v[146:147], v192 offset:41984
  v_mfma_f32_32x32x16_bf16 v[80:95], v[160:163], v[172:175], v[80:95]
  ds_read_b128 v[152:155], v196 offset:32768
  ds_read_b128 v[156:159], v196 offset:36864
  v_mfma_f32_32x32x16_bf16 v[96:111], v[164:167], v[168:171], v[96:111]
  ds_read_b64_tr_b16 v[148:149], v193 offset:40960
  ds_read_b64_tr_b16 v[150:151], v193 offset:41984
  v_mfma_f32_32x32x16_bf16 v[112:127], v[164:167], v[172:175], v[112:127]
  s_waitcnt lgkmcnt(6)
  v_mfma_f32_32x32x16_bf16 v[64:79], v[128:131], v[136:139], v[64:79]
  ds_read_b64_tr_b16 v[160:161], v192 offset:45056
  ds_read_b64_tr_b16 v[162:163], v192 offset:46080
  v_mfma_f32_32x32x16_bf16 v[80:95], v[128:131], v[140:143], v[80:95]
  ds_read_b128 v[168:171], v197 offset:32768
  ds_read_b128 v[172:175], v197 offset:36864
  v_mfma_f32_32x32x16_bf16 v[96:111], v[132:135], v[136:139], v[96:111]
  ds_read_b64_tr_b16 v[164:165], v193 offset:45056
  ds_read_b64_tr_b16 v[166:167], v193 offset:46080
  v_mfma_f32_32x32x16_bf16 v[112:127], v[132:135], v[140:143], v[112:127]
  s_waitcnt lgkmcnt(0)
  s_barrier
  v_mfma_f32_32x32x16_bf16 v[64:79], v[144:147], v[152:155], v[64:79]
  ds_read_b64_tr_b16 v[128:129], v192 offset:0
  ds_read_b64_tr_b16 v[130:131], v192 offset:1024
  v_mfma_f32_32x32x16_bf16 v[80:95], v[144:147], v[156:159], v[80:95]
  ds_read_b128 v[136:139], v194 offset:0
  ds_read_b128 v[140:143], v194 offset:4096
  v_mfma_f32_32x32x16_bf16 v[96:111], v[148:151], v[152:155], v[96:111]
  ds_read_b64_tr_b16 v[132:133], v193 offset:0
  ds_read_b64_tr_b16 v[134:135], v193 offset:1024
  v_mfma_f32_32x32x16_bf16 v[112:127], v[148:151], v[156:159], v[112:127]
  v_mfma_f32_32x32x16_bf16 v[64:79], v[160:163], v[168:171], v[64:79]
  ds_read_b64_tr_b16 v[144:145], v192 offset:4096
  ds_read_b64_tr_b16 v[146:147], v192 offset:5120
  v_mfma_f32_32x32x16_bf16 v[80:95], v[160:163], v[172:175], v[80:95]
  ds_read_b128 v[152:155], v195 offset:0
  ds_read_b128 v[156:159], v195 offset:4096
  v_mfma_f32_32x32x16_bf16 v[96:111], v[164:167], v[168:171], v[96:111]
  ds_read_b64_tr_b16 v[148:149], v193 offset:4096
  ds_read_b64_tr_b16 v[150:151], v193 offset:5120
  v_mfma_f32_32x32x16_bf16 v[112:127], v[164:167], v[172:175], v[112:127]
  s_waitcnt lgkmcnt(6)
  v_mfma_f32_32x32x16_bf16 v[64:79], v[128:131], v[136:139], v[64:79]
  ds_read_b64_tr_b16 v[160:161], v192 offset:8192
  ds_read_b64_tr_b16 v[162:163], v192 offset:9216
  v_mfma_f32_32x32x16_bf16 v[80:95], v[128:131], v[140:143], v[80:95]
  ds_read_b128 v[168:171], v196 offset:0
  ds_read_b128 v[172:175], v196 offset:4096
  v_mfma_f32_32x32x16_bf16 v[96:111], v[132:135], v[136:139], v[96:111]
  ds_read_b64_tr_b16 v[164:165], v193 offset:8192
  ds_read_b64_tr_b16 v[166:167], v193 offset:9216
  v_mfma_f32_32x32x16_bf16 v[112:127], v[132:135], v[140:143], v[112:127]
  s_waitcnt lgkmcnt(6)
  v_mfma_f32_32x32x16_bf16 v[64:79], v[144:147], v[152:155], v[64:79]
  ds_read_b64_tr_b16 v[128:129], v192 offset:12288
  ds_read_b64_tr_b16 v[130:131], v192 offset:13312
  v_mfma_f32_32x32x16_bf16 v[80:95], v[144:147], v[156:159], v[80:95]
  ds_read_b128 v[136:139], v197 offset:0
  ds_read_b128 v[140:143], v197 offset:4096
  v_mfma_f32_32x32x16_bf16 v[96:111], v[148:151], v[152:155], v[96:111]
  ds_read_b64_tr_b16 v[132:133], v193 offset:12288
  ds_read_b64_tr_b16 v[134:135], v193 offset:13312
  v_mfma_f32_32x32x16_bf16 v[112:127], v[148:151], v[156:159], v[112:127]
  s_waitcnt lgkmcnt(0)
  s_barrier
  v_mfma_f32_32x32x16_bf16 v[64:79], v[160:163], v[168:171], v[64:79]
  v_mfma_f32_32x32x16_bf16 v[80:95], v[160:163], v[172:175], v[80:95]
  v_mfma_f32_32x32x16_bf16 v[96:111], v[164:167], v[168:171], v[96:111]
  v_mfma_f32_32x32x16_bf16 v[112:127], v[164:167], v[172:175], v[112:127]
  s_add_u32 m0, s61, 131072
  s_add_u32 s58, s75, 0
  s_and_b32 s58, s58, 7
  s_lshl_b32 s58, s58, 14
  s_add_u32 s58, s58, s61
  buffer_load_dwordx4 v32, s[40:43], s58 offen offset:0 nt lds
  buffer_load_dwordx4 v32, s[40:43], s58 offen offset:1024 nt lds
  buffer_load_dwordx4 v32, s[40:43], s58 offen offset:2048 nt lds
  buffer_load_dwordx4 v32, s[40:43], s58 offen offset:3072 nt lds
  v_mfma_f32_32x32x16_bf16 v[64:79], v[128:131], v[136:139], v[64:79]
  v_mfma_f32_32x32x16_bf16 v[80:95], v[128:131], v[140:143], v[80:95]
  v_mfma_f32_32x32x16_bf16 v[96:111], v[132:135], v[136:139], v[96:111]
  v_mfma_f32_32x32x16_bf16 v[112:127], v[132:135], v[140:143], v[112:127]
  s_nop 7
  s_nop 3
  v_mul_f32 v64, s52, v64
  v_mul_f32 v65, s52, v65
  v_mul_f32 v66, s52, v66
  v_mul_f32 v67, s52, v67
  v_mul_f32 v68, s52, v68
  v_mul_f32 v69, s52, v69
  v_mul_f32 v70, s52, v70
  v_mul_f32 v71, s52, v71
  v_mul_f32 v72, s52, v72
  v_mul_f32 v73, s52, v73
  v_mul_f32 v74, s52, v74
  v_mul_f32 v75, s52, v75
  v_mul_f32 v76, s52, v76
  v_mul_f32 v77, s52, v77
  v_mul_f32 v78, s52, v78
  v_mul_f32 v79, s52, v79
  v_mul_f32 v80, s52, v80
  v_mul_f32 v81, s52, v81
  v_mul_f32 v82, s52, v82
  v_mul_f32 v83, s52, v83
  v_mul_f32 v84, s52, v84
  v_mul_f32 v85, s52, v85
  v_mul_f32 v86, s52, v86
  v_mul_f32 v87, s52, v87
  v_mul_f32 v88, s52, v88
  v_mul_f32 v89, s52, v89
  v_mul_f32 v90, s52, v90
  v_mul_f32 v91, s52, v91
  v_mul_f32 v92, s52, v92
  v_mul_f32 v93, s52, v93
  v_mul_f32 v94, s52, v94
  v_mul_f32 v95, s52, v95
  v_mul_f32 v96, s52, v96
  v_mul_f32 v97, s52, v97
  v_mul_f32 v98, s52, v98
  v_mul_f32 v99, s52, v99
  v_mul_f32 v100, s52, v100
  v_mul_f32 v101, s52, v101
  v_mul_f32 v102, s52, v102
  v_mul_f32 v103, s52, v103
  v_mul_f32 v104, s52, v104
  v_mul_f32 v105, s52, v105
  v_mul_f32 v106, s52, v106
  v_mul_f32 v107, s52, v107
  v_mul_f32 v108, s52, v108
  v_mul_f32 v109, s52, v109
  v_mul_f32 v110, s52, v110
  v_mul_f32 v111, s52, v111
  v_mul_f32 v112, s52, v112
  v_mul_f32 v113, s52, v113
  v_mul_f32 v114, s52, v114
  v_mul_f32 v115, s52, v115
  v_mul_f32 v116, s52, v116
  v_mul_f32 v117, s52, v117
  v_mul_f32 v118, s52, v118
  v_mul_f32 v119, s52, v119
  v_mul_f32 v120, s52, v120
  v_mul_f32 v121, s52, v121
  v_mul_f32 v122, s52, v122
  v_mul_f32 v123, s52, v123
  v_mul_f32 v124, s52, v124
  v_mul_f32 v125, s52, v125
  v_mul_f32 v126, s52, v126
  v_mul_f32 v127, s52, v127
  s_and_b32 s56, s20, 1
  s_cmp_eq_u32 s56, 1
  s_cbranch_scc1 L_QX1
  v_cvt_pk_bf16_f32 v128, v80, v81
  v_cvt_pk_bf16_f32 v129, v82, v83
  v_cvt_pk_bf16_f32 v130, v84, v85
  v_cvt_pk_bf16_f32 v131, v86, v87
  v_cvt_pk_bf16_f32 v132, v88, v89
  v_cvt_pk_bf16_f32 v133, v90, v91
  v_cvt_pk_bf16_f32 v134, v92, v93
  v_cvt_pk_bf16_f32 v135, v94, v95
  v_cvt_pk_bf16_f32 v136, v112, v113
  v_cvt_pk_bf16_f32 v137, v114, v115
  v_cvt_pk_bf16_f32 v138, v116, v117
  v_cvt_pk_bf16_f32 v139, v118, v119
  v_cvt_pk_bf16_f32 v140, v120, v121
  v_cvt_pk_bf16_f32 v141, v122, v123
  v_cvt_pk_bf16_f32 v142, v124, v125
  v_cvt_pk_bf16_f32 v143, v126, v127
  v_add_u32 v1, s61, v33
  s_xor_b32 s54, s61, 4096
  v_add_u32 v2, s54, v33
  ds_write_b128 v1, v[128:131] offset:0
  ds_write_b128 v1, v[132:135] offset:1024
  ds_write_b128 v1, v[136:139] offset:2048
  ds_write_b128 v1, v[140:143] offset:3072
  v_cvt_pk_bf16_f32 v224, v64, v65
  v_cvt_pk_bf16_f32 v225, v66, v67
  v_cvt_pk_bf16_f32 v226, v68, v69
  v_cvt_pk_bf16_f32 v227, v70, v71
  v_cvt_pk_bf16_f32 v228, v72, v73
  v_cvt_pk_bf16_f32 v229, v74, v75
  v_cvt_pk_bf16_f32 v230, v76, v77
  v_cvt_pk_bf16_f32 v231, v78, v79
  v_cvt_pk_bf16_f32 v232, v96, v97
  v_cvt_pk_bf16_f32 v233, v98, v99
  v_cvt_pk_bf16_f32 v234, v100, v101
  v_cvt_pk_bf16_f32 v235, v102, v103
  v_cvt_pk_bf16_f32 v236, v104, v105
  v_cvt_pk_bf16_f32 v237, v106, v107
  v_cvt_pk_bf16_f32 v238, v108, v109
  v_cvt_pk_bf16_f32 v239, v110, v111
  s_waitcnt lgkmcnt(0)
  s_barrier
  ds_read_b128 v[240:243], v2 offset:0
  ds_read_b128 v[244:247], v2 offset:1024
  ds_read_b128 v[248:251], v2 offset:2048
  ds_read_b128 v[252:255], v2 offset:3072
  s_branch L_QXD
L_QX1:
  v_cvt_pk_bf16_f32 v128, v64, v65
  v_cvt_pk_bf16_f32 v129, v66, v67
  v_cvt_pk_bf16_f32 v130, v68, v69
  v_cvt_pk_bf16_f32 v131, v70, v71
  v_cvt_pk_bf16_f32 v132, v72, v73
  v_cvt_pk_bf16_f32 v133, v74, v75
  v_cvt_pk_bf16_f32 v134, v76, v77
  v_cvt_pk_bf16_f32 v135, v78, v79
  v_cvt_pk_bf16_f32 v136, v96, v97
  v_cvt_pk_bf16_f32 v137, v98, v99
  v_cvt_pk_bf16_f32 v138, v100, v101
  v_cvt_pk_bf16_f32 v139, v102, v103
  v_cvt_pk_bf16_f32 v140, v104, v105
  v_cvt_pk_bf16_f32 v141, v106, v107
  v_cvt_pk_bf16_f32 v142, v108, v109
  v_cvt_pk_bf16_f32 v143, v110, v111
  v_add_u32 v1, s61, v33
  s_xor_b32 s54, s61, 4096
  v_add_u32 v2, s54, v33
  ds_write_b128 v1, v[128:131] offset:0
  ds_write_b128 v1, v[132:135] offset:1024
  ds_write_b128 v1, v[136:139] offset:2048
  ds_write_b128 v1, v[140:143] offset:3072
  v_cvt_pk_bf16_f32 v240, v80, v81
  v_cvt_pk_bf16_f32 v241, v82, v83
  v_cvt_pk_bf16_f32 v242, v84, v85
  v_cvt_pk_bf16_f32 v243, v86, v87
  v_cvt_pk_bf16_f32 v244, v88, v89
  v_cvt_pk_bf16_f32 v245, v90, v91
  v_cvt_pk_bf16_f32 v246, v92, v93
  v_cvt_pk_bf16_f32 v247, v94, v95
  v_cvt_pk_bf16_f32 v248, v112, v113
  v_cvt_pk_bf16_f32 v249, v114, v115
  v_cvt_pk_bf16_f32 v250, v116, v117
  v_cvt_pk_bf16_f32 v251, v118, v119
  v_cvt_pk_bf16_f32 v252, v120, v121
  v_cvt_pk_bf16_f32 v253, v122, v123
  v_cvt_pk_bf16_f32 v254, v124, v125
  v_cvt_pk_bf16_f32 v255, v126, v127
  s_waitcnt lgkmcnt(0)
  s_barrier
  ds_read_b128 v[224:227], v2 offset:0
  ds_read_b128 v[228:231], v2 offset:1024
  ds_read_b128 v[232:235], v2 offset:2048
  ds_read_b128 v[236:239], v2 offset:3072
L_QXD:
  v_add_u32 v16, 0x18000, v16
  v_add_u32 v17, 0x18000, v17
  v_add_u32 v18, 0x18000, v18
  v_add_u32 v19, 0x18000, v19
  v_add_u32 v20, 0x18000, v20
  v_add_u32 v21, 0x18000, v21
  v_add_u32 v22, 0x18000, v22
  v_add_u32 v23, 0x18000, v23
  s_waitcnt vmcnt(8) lgkmcnt(0)
  s_barrier
  ds_read_b128 v[34:37], v16 offset:0
  ds_read_b128 v[38:41], v17 offset:0
  ds_read_b128 v[42:45], v18 offset:0
  ds_read_b128 v[46:49], v19 offset:0
  ds_read_b128 v[50:53], v20 offset:0
  s_waitcnt lgkmcnt(3)
  v_mfma_f32_32x32x16_bf16 v[128:143], v[34:37], v[224:227], 0
  ds_read_b128 v[54:57], v21 offset:0
  s_add_u32 m0, s61, 147456
  s_add_u32 s58, s75, 2
  s_and_b32 s58, s58, 7
  s_lshl_b32 s58, s58, 14
  s_add_u32 s58, s58, s61
  buffer_load_dwordx4 v28, s[36:39], s58 offen offset:0 nt lds
  buffer_load_dwordx4 v29, s[36:39], s58 offen offset:1024 nt lds
  buffer_load_dwordx4 v30, s[36:39], s58 offen offset:2048 nt lds
  buffer_load_dwordx4 v31, s[36:39], s58 offen offset:3072 nt lds
  v_mfma_f32_32x32x16_bf16 v[128:143], v[38:41], v[228:231], v[128:143]
  ds_read_b128 v[58:61], v22 offset:0
  s_waitcnt lgkmcnt(3)
  v_mfma_f32_32x32x16_bf16 v[128:143], v[42:45], v[232:235], v[128:143]
  ds_read_b128 v[34:37], v23 offset:0
  v_mfma_f32_32x32x16_bf16 v[128:143], v[46:49], v[236:239], v[128:143]
  ds_read_b128 v[38:41], v16 offset:8192
  s_waitcnt lgkmcnt(3)
  v_mfma_f32_32x32x16_bf16 v[128:143], v[50:53], v[240:243], v[128:143]
  ds_read_b128 v[42:45], v17 offset:8192
  v_mfma_f32_32x32x16_bf16 v[128:143], v[54:57], v[244:247], v[128:143]
  ds_read_b128 v[46:49], v18 offset:8192
  s_waitcnt lgkmcnt(3)
  v_mfma_f32_32x32x16_bf16 v[128:143], v[58:61], v[248:251], v[128:143]
  ds_read_b128 v[50:53], v19 offset:8192
  v_mfma_f32_32x32x16_bf16 v[128:143], v[34:37], v[252:255], v[128:143]
  ds_read_b128 v[54:57], v20 offset:8192
  s_waitcnt lgkmcnt(3)
  v_mfma_f32_32x32x16_bf16 v[144:159], v[38:41], v[224:227], 0
  ds_read_b128 v[58:61], v21 offset:8192
  v_mfma_f32_32x32x16_bf16 v[144:159], v[42:45], v[228:231], v[144:159]
  ds_read_b128 v[34:37], v22 offset:8192
  s_waitcnt lgkmcnt(3)
  v_mfma_f32_32x32x16_bf16 v[144:159], v[46:49], v[232:235], v[144:159]
  ds_read_b128 v[38:41], v23 offset:8192
  v_mfma_f32_32x32x16_bf16 v[144:159], v[50:53], v[236:239], v[144:159]
  s_waitcnt lgkmcnt(2)
  v_mfma_f32_32x32x16_bf16 v[144:159], v[54:57], v[240:243], v[144:159]
  v_mfma_f32_32x32x16_bf16 v[144:159], v[58:61], v[244:247], v[144:159]
  s_waitcnt lgkmcnt(0)
  v_mfma_f32_32x32x16_bf16 v[144:159], v[34:37], v[248:251], v[144:159]
  v_mfma_f32_32x32x16_bf16 v[144:159], v[38:41], v[252:255], v[144:159]
  s_nop 7
  s_nop 3
  v_max3_f32 v8, v128, v129, v130
  v_max3_f32 v9, v144, v145, v146
  v_max3_f32 v8, v8, v131, v132
  v_max3_f32 v9, v9, v147, v148
  v_max3_f32 v8, v8, v133, v134
  v_max3_f32 v9, v9, v149, v150
  v_max3_f32 v8, v8, v135, v136
  v_max3_f32 v9, v9, v151, v152
  v_max3_f32 v8, v8, v137, v138
  v_max3_f32 v9, v9, v153, v154
  v_max3_f32 v8, v8, v139, v140
  v_max3_f32 v9, v9, v155, v156
  v_max3_f32 v8, v8, v141, v142
  v_max3_f32 v9, v9, v157, v158
  v_max3_f32 v8, v8, v143, v159
  v_max_f32 v8, v8, v9
  v_mov_b32 v9, v8
  s_nop 1
  v_permlane32_swap_b32 v8, v9
  v_max_f32 v8, v8, v9
  v_sub_f32 v208, 0, v8
  v_sub_f32 v209, 0, v8
  v_sub_f32 v210, 0, v8
  v_sub_f32 v211, 0, v8
  v_sub_f32 v212, 0, v8
  v_sub_f32 v213, 0, v8
  v_sub_f32 v214, 0, v8
  v_sub_f32 v215, 0, v8
  v_sub_f32 v216, 0, v8
  v_sub_f32 v217, 0, v8
  v_sub_f32 v218, 0, v8
  v_sub_f32 v219, 0, v8
  v_sub_f32 v220, 0, v8
  v_sub_f32 v221, 0, v8
  v_sub_f32 v222, 0, v8
  v_sub_f32 v223, 0, v8
  v_sub_f32 v128, v128, v8
  v_sub_f32 v129, v129, v8
  v_sub_f32 v130, v130, v8
  v_sub_f32 v131, v131, v8
  v_sub_f32 v132, v132, v8
  v_sub_f32 v133, v133, v8
  v_sub_f32 v134, v134, v8
  v_sub_f32 v135, v135, v8
  v_sub_f32 v136, v136, v8
  v_sub_f32 v137, v137, v8
  v_sub_f32 v138, v138, v8
  v_sub_f32 v139, v139, v8
  v_sub_f32 v140, v140, v8
  v_sub_f32 v141, v141, v8
  v_sub_f32 v142, v142, v8
  v_sub_f32 v143, v143, v8
  v_sub_f32 v144, v144, v8
  v_sub_f32 v145, v145, v8
  v_sub_f32 v146, v146, v8
  v_sub_f32 v147, v147, v8
  v_sub_f32 v148, v148, v8
  v_sub_f32 v149, v149, v8
  v_sub_f32 v150, v150, v8
  v_sub_f32 v151, v151, v8
  v_sub_f32 v152, v152, v8
  v_sub_f32 v153, v153, v8
  v_sub_f32 v154, v154, v8
  v_sub_f32 v155, v155, v8
  v_sub_f32 v156, v156, v8
  v_sub_f32 v157, v157, v8
  v_sub_f32 v158, v158, v8
  v_sub_f32 v159, v159, v8
  v_add_u32 v16, 0x4000, v16
  v_add_u32 v17, 0x4000, v17
  v_add_u32 v18, 0x4000, v18
  v_add_u32 v19, 0x4000, v19
  v_add_u32 v20, 0x4000, v20
  v_add_u32 v21, 0x4000, v21
  v_add_u32 v22, 0x4000, v22
  v_add_u32 v23, 0x4000, v23
  s_waitcnt vmcnt(8) lgkmcnt(0)
  s_barrier
  ds_read_b128 v[34:37], v16 offset:0
  ds_read_b128 v[38:41], v17 offset:0
  ds_read_b128 v[42:45], v18 offset:0
  ds_read_b128 v[46:49], v19 offset:0
  ds_read_b128 v[50:53], v20 offset:0
  s_waitcnt lgkmcnt(3)
  v_mfma_f32_32x32x16_bf16 v[160:175], v[34:37], v[224:227], v[208:223]
  ds_read_b128 v[54:57], v21 offset:0
  s_add_u32 m0, s61, 98304
  s_add_u32 s58, s75, 1
  s_and_b32 s58, s58, 7
  s_lshl_b32 s58, s58, 14
  s_add_u32 s58, s58, s61
  buffer_load_dwordx4 v32, s[40:43], s58 offen offset:0 nt lds
  buffer_load_dwordx4 v32, s[40:43], s58 offen offset:1024 nt lds
  buffer_load_dwordx4 v32, s[40:43], s58 offen offset:2048 nt lds
  buffer_load_dwordx4 v32, s[40:43], s58 offen offset:3072 nt lds
  v_exp_f32 v128, v128
  v_exp_f32 v129, v129
  v_exp_f32 v130, v130
  v_exp_f32 v131, v131
  v_exp_f32 v132, v132
  v_exp_f32 v133, v133
  v_mfma_f32_32x32x16_bf16 v[160:175], v[38:41], v[228:231], v[160:175]
  ds_read_b128 v[58:61], v22 offset:0
  v_exp_f32 v134, v134
  v_exp_f32 v135, v135
  v_exp_f32 v136, v136
  v_exp_f32 v137, v137
  v_exp_f32 v138, v138
  s_waitcnt lgkmcnt(3)
  v_mfma_f32_32x32x16_bf16 v[160:175], v[42:45], v[232:235], v[160:175]
  ds_read_b128 v[34:37], v23 offset:0
  v_exp_f32 v139, v139
  v_exp_f32 v140, v140
  v_exp_f32 v141, v141
  v_exp_f32 v142, v142
  v_exp_f32 v143, v143
  v_mfma_f32_32x32x16_bf16 v[160:175], v[46:49], v[236:239], v[160:175]
  ds_read_b128 v[38:41], v16 offset:8192
  v_exp_f32 v144, v144
  v_exp_f32 v145, v145
  v_exp_f32 v146, v146
  v_exp_f32 v147, v147
  v_exp_f32 v148, v148
  s_waitcnt lgkmcnt(3)
  v_mfma_f32_32x32x16_bf16 v[160:175], v[50:53], v[240:243], v[160:175]
  ds_read_b128 v[42:45], v17 offset:8192
  v_exp_f32 v149, v149
  v_exp_f32 v150, v150
  v_exp_f32 v151, v151
  v_exp_f32 v152, v152
  v_exp_f32 v153, v153
  v_mfma_f32_32x32x16_bf16 v[160:175], v[54:57], v[244:247], v[160:175]
  ds_read_b128 v[46:49], v18 offset:8192
  v_exp_f32 v154, v154
  v_exp_f32 v155, v155
  v_exp_f32 v156, v156
  v_exp_f32 v157, v157
  v_exp_f32 v158, v158
  s_waitcnt lgkmcnt(3)
  v_mfma_f32_32x32x16_bf16 v[160:175], v[58:61], v[248:251], v[160:175]
  ds_read_b128 v[50:53], v19 offset:8192
  v_exp_f32 v159, v159
  s_nop 0
  v_mov_b32 v10, v128
  v_mov_b32 v11, v129
  v_cvt_pk_bf16_f32 v192, v128, v129
  v_mfma_f32_32x32x16_bf16 v[160:175], v[34:37], v[252:255], v[160:175]
  ds_read_b128 v[54:57], v20 offset:8192
  v_add_f32 v10, v10, v130
  v_add_f32 v11, v11, v131
  v_cvt_pk_bf16_f32 v193, v130, v131
  v_add_f32 v10, v10, v132
  v_add_f32 v11, v11, v133
  s_waitcnt lgkmcnt(3)
  v_mfma_f32_32x32x16_bf16 v[176:191], v[38:41], v[224:227], v[208:223]
  ds_read_b128 v[58:61], v21 offset:8192
  v_cvt_pk_bf16_f32 v194, v132, v133
  v_add_f32 v10, v10, v134
  v_add_f32 v11, v11, v135
  v_cvt_pk_bf16_f32 v195, v134, v135
  v_add_f32 v10, v10, v136
  v_mfma_f32_32x32x16_bf16 v[176:191], v[42:45], v[228:231], v[176:191]
  ds_read_b128 v[34:37], v22 offset:8192
  v_add_f32 v11, v11, v137
  v_cvt_pk_bf16_f32 v196, v136, v137
  v_add_f32 v10, v10, v138
  v_add_f32 v11, v11, v139
  v_cvt_pk_bf16_f32 v197, v138, v139
  s_waitcnt lgkmcnt(3)
  v_mfma_f32_32x32x16_bf16 v[176:191], v[46:49], v[232:235], v[176:191]
  ds_read_b128 v[38:41], v23 offset:8192
  v_add_f32 v10, v10, v140
  v_add_f32 v11, v11, v141
  v_cvt_pk_bf16_f32 v198, v140, v141
  v_add_f32 v10, v10, v142
  v_add_f32 v11, v11, v143
  v_mfma_f32_32x32x16_bf16 v[176:191], v[50:53], v[236:239], v[176:191]
  v_cvt_pk_bf16_f32 v199, v142, v143
  v_add_f32 v10, v10, v144
  v_add_f32 v11, v11, v145
  v_cvt_pk_bf16_f32 v200, v144, v145
  v_add_f32 v10, v10, v146
  s_waitcnt lgkmcnt(2)
  v_mfma_f32_32x32x16_bf16 v[176:191], v[54:57], v[240:243], v[176:191]
  v_add_f32 v11, v11, v147
  v_cvt_pk_bf16_f32 v201, v146, v147
  v_add_f32 v10, v10, v148
  v_add_f32 v11, v11, v149
  v_cvt_pk_bf16_f32 v202, v148, v149
  v_mfma_f32_32x32x16_bf16 v[176:191], v[58:61], v[244:247], v[176:191]
  v_add_f32 v10, v10, v150
  v_add_f32 v11, v11, v151
  v_cvt_pk_bf16_f32 v203, v150, v151
  v_add_f32 v10, v10, v152
  v_add_f32 v11, v11, v153
  s_waitcnt lgkmcnt(0)
  v_mfma_f32_32x32x16_bf16 v[176:191], v[34:37], v[248:251], v[176:191]
  v_cvt_pk_bf16_f32 v204, v152, v153
  v_add_f32 v10, v10, v154
  v_add_f32 v11, v11, v155
  v_cvt_pk_bf16_f32 v205, v154, v155
  v_add_f32 v10, v10, v156
  v_mfma_f32_32x32x16_bf16 v[176:191], v[38:41], v[252:255], v[176:191]
  v_add_f32 v11, v11, v157
  v_cvt_pk_bf16_f32 v206, v156, v157
  v_add_f32 v10, v10, v158
  v_add_f32 v11, v11, v159
  v_cvt_pk_bf16_f32 v207, v158, v159
  v_add_u32 v24, 0x20000, v24
  v_add_u32 v25, 0x20000, v25
  v_add_u32 v26, 0x20000, v26
  v_add_u32 v27, 0x20000, v27
  s_waitcnt vmcnt(8) lgkmcnt(0)
  s_barrier
  ds_read_b64_tr_b16 v[34:35], v24 offset:0
  ds_read_b64_tr_b16 v[36:37], v24 offset:2048
  ds_read_b64_tr_b16 v[38:39], v25 offset:0
  ds_read_b64_tr_b16 v[40:41], v25 offset:2048
  ds_read_b64_tr_b16 v[42:43], v26 offset:0
  ds_read_b64_tr_b16 v[44:45], v26 offset:2048
  ds_read_b64_tr_b16 v[46:47], v27 offset:0
  ds_read_b64_tr_b16 v[48:49], v27 offset:2048
  ds_read_b64_tr_b16 v[50:51], v24 offset:4096
  ds_read_b64_tr_b16 v[52:53], v24 offset:6144
  s_waitcnt lgkmcnt(6)
  v_mfma_f32_32x32x16_bf16 v[64:79], v[34:37], v[192:195], 0
  ds_read_b64_tr_b16 v[54:55], v25 offset:4096
  ds_read_b64_tr_b16 v[56:57], v25 offset:6144
  s_add_u32 m0, s61, 114688
  s_add_u32 s58, s75, 3
  s_and_b32 s58, s58, 7
  s_lshl_b32 s58, s58, 14
  s_add_u32 s58, s58, s61
  buffer_load_dwordx4 v28, s[36:39], s58 offen offset:0 nt lds
  buffer_load_dwordx4 v29, s[36:39], s58 offen offset:1024 nt lds
  buffer_load_dwordx4 v30, s[36:39], s58 offen offset:2048 nt lds
  buffer_load_dwordx4 v31, s[36:39], s58 offen offset:3072 nt lds
  v_max3_f32 v8, v160, v161, v162
  v_max3_f32 v9, v176, v177, v178
  v_max3_f32 v8, v8, v163, v164
  v_max3_f32 v9, v9, v179, v180
  v_mfma_f32_32x32x16_bf16 v[80:95], v[38:41], v[192:195], 0
  ds_read_b64_tr_b16 v[58:59], v26 offset:4096
  ds_read_b64_tr_b16 v[60:61], v26 offset:6144
  v_max3_f32 v8, v8, v165, v166
  v_max3_f32 v9, v9, v181, v182
  v_max3_f32 v8, v8, v167, v168
  v_max3_f32 v9, v9, v183, v184
  s_waitcnt lgkmcnt(6)
  v_mfma_f32_32x32x16_bf16 v[96:111], v[42:45], v[192:195], 0
  ds_read_b64_tr_b16 v[34:35], v27 offset:4096
  ds_read_b64_tr_b16 v[36:37], v27 offset:6144
  v_max3_f32 v8, v8, v169, v170
  v_max3_f32 v9, v9, v185, v186
  v_max3_f32 v8, v8, v171, v172
  v_max3_f32 v9, v9, v187, v188
  v_mfma_f32_32x32x16_bf16 v[112:127], v[46:49], v[192:195], 0
  ds_read_b64_tr_b16 v[38:39], v24 offset:8192
  ds_read_b64_tr_b16 v[40:41], v24 offset:10240
  v_max3_f32 v8, v8, v173, v174
  v_max3_f32 v9, v9, v189, v190
  v_max3_f32 v8, v8, v175, v191
  v_max_f32 v8, v8, v9
  s_waitcnt lgkmcnt(6)
  v_mfma_f32_32x32x16_bf16 v[64:79], v[50:53], v[196:199], v[64:79]
  ds_read_b64_tr_b16 v[42:43], v25 offset:8192
  ds_read_b64_tr_b16 v[44:45], v25 offset:10240
  v_mov_b32 v9, v8
  s_nop 1
  v_permlane32_swap_b32 v8, v9
  v_max_f32 v8, v8, v9
  v_cmp_lt_f32 vcc, s64, v8
  s_mov_b32 s65, 0
  s_cmp_lg_u64 vcc, 0
  s_cbranch_scc1 K1_RO1
K1_R1:
  v_mfma_f32_32x32x16_bf16 v[80:95], v[54:57], v[196:199], v[80:95]
  ds_read_b64_tr_b16 v[46:47], v26 offset:8192
  ds_read_b64_tr_b16 v[48:49], v26 offset:10240
  v_exp_f32 v160, v160
  v_exp_f32 v161, v161
  s_waitcnt lgkmcnt(6)
  v_mfma_f32_32x32x16_bf16 v[96:111], v[58:61], v[196:199], v[96:111]
  ds_read_b64_tr_b16 v[50:51], v27 offset:8192
  ds_read_b64_tr_b16 v[52:53], v27 offset:10240
  v_exp_f32 v162, v162
  v_exp_f32 v163, v163
  v_mfma_f32_32x32x16_bf16 v[112:127], v[34:37], v[196:199], v[112:127]
  ds_read_b64_tr_b16 v[54:55], v24 offset:12288
  ds_read_b64_tr_b16 v[56:57], v24 offset:14336
  v_exp_f32 v164, v164
  s_waitcnt lgkmcnt(6)
  v_mfma_f32_32x32x16_bf16 v[64:79], v[38:41], v[200:203], v[64:79]
  ds_read_b64_tr_b16 v[58:59], v25 offset:12288
  ds_read_b64_tr_b16 v[60:61], v25 offset:14336
  v_exp_f32 v165, v165
  v_exp_f32 v166, v166
  v_mfma_f32_32x32x16_bf16 v[80:95], v[42:45], v[200:203], v[80:95]
  ds_read_b64_tr_b16 v[34:35], v26 offset:12288
  ds_read_b64_tr_b16 v[36:37], v26 offset:14336
  v_exp_f32 v167, v167
  v_exp_f32 v168, v168
  s_waitcnt lgkmcnt(6)
  v_mfma_f32_32x32x16_bf16 v[96:111], v[46:49], v[200:203], v[96:111]
  ds_read_b64_tr_b16 v[38:39], v27 offset:12288
  ds_read_b64_tr_b16 v[40:41], v27 offset:14336
  v_exp_f32 v169, v169
  v_mfma_f32_32x32x16_bf16 v[112:127], v[50:53], v[200:203], v[112:127]
  v_exp_f32 v170, v170
  v_exp_f32 v171, v171
  s_waitcnt lgkmcnt(4)
  v_mfma_f32_32x32x16_bf16 v[64:79], v[54:57], v[204:207], v[64:79]
  v_exp_f32 v172, v172
  v_exp_f32 v173, v173
  v_mfma_f32_32x32x16_bf16 v[80:95], v[58:61], v[204:207], v[80:95]
  v_exp_f32 v174, v174
  s_waitcnt lgkmcnt(0)
  v_mfma_f32_32x32x16_bf16 v[96:111], v[34:37], v[204:207], v[96:111]
  v_exp_f32 v175, v175
  v_exp_f32 v176, v176
  v_mfma_f32_32x32x16_bf16 v[112:127], v[38:41], v[204:207], v[112:127]
  v_exp_f32 v177, v177
  v_add_u32 v16, 0x8000, v16
  v_add_u32 v17, 0x8000, v17
  v_add_u32 v18, 0x8000, v18
  v_add_u32 v19, 0x8000, v19
  v_add_u32 v20, 0x8000, v20
  v_add_u32 v21, 0x8000, v21
  v_add_u32 v22, 0x8000, v22
  v_add_u32 v23, 0x8000, v23
  s_waitcnt vmcnt(8) lgkmcnt(0)
  s_barrier
  ds_read_b128 v[34:37], v16 offset:0
  ds_read_b128 v[38:41], v17 offset:0
  ds_read_b128 v[42:45], v18 offset:0
  ds_read_b128 v[46:49], v19 offset:0
  ds_read_b128 v[50:53], v20 offset:0
  s_waitcnt lgkmcnt(3)
  v_mfma_f32_32x32x16_bf16 v[128:143], v[34:37], v[224:227], v[208:223]
  ds_read_b128 v[54:57], v21 offset:0
  s_add_u32 m0, s61, 131072
  s_add_u32 s58, s75, 2
  s_and_b32 s58, s58, 7
  s_lshl_b32 s58, s58, 14
  s_add_u32 s58, s58, s61
  buffer_load_dwordx4 v32, s[40:43], s58 offen offset:0 nt lds
  buffer_load_dwordx4 v32, s[40:43], s58 offen offset:1024 nt lds
  buffer_load_dwordx4 v32, s[40:43], s58 offen offset:2048 nt lds
  buffer_load_dwordx4 v32, s[40:43], s58 offen offset:3072 nt lds
  v_exp_f32 v178, v178
  v_exp_f32 v179, v179
  v_exp_f32 v180, v180
  v_exp_f32 v181, v181
  v_mfma_f32_32x32x16_bf16 v[128:143], v[38:41], v[228:231], v[128:143]
  ds_read_b128 v[58:61], v22 offset:0
  v_exp_f32 v182, v182
  v_exp_f32 v183, v183
  v_exp_f32 v184, v184
  v_exp_f32 v185, v185
  s_waitcnt lgkmcnt(3)
  v_mfma_f32_32x32x16_bf16 v[128:143], v[42:45], v[232:235], v[128:143]
  ds_read_b128 v[34:37], v23 offset:0
  v_exp_f32 v186, v186
  v_exp_f32 v187, v187
  v_exp_f32 v188, v188
  v_exp_f32 v189, v189
  v_mfma_f32_32x32x16_bf16 v[128:143], v[46:49], v[236:239], v[128:143]
  ds_read_b128 v[38:41], v16 offset:8192
  v_exp_f32 v190, v190
  v_exp_f32 v191, v191
  v_add_f32 v10, v10, v160
  v_add_f32 v11, v11, v161
  s_waitcnt lgkmcnt(3)
  v_mfma_f32_32x32x16_bf16 v[128:143], v[50:53], v[240:243], v[128:143]
  ds_read_b128 v[42:45], v17 offset:8192
  v_cvt_pk_bf16_f32 v192, v160, v161
  v_add_f32 v10, v10, v162
  v_add_f32 v11, v11, v163
  v_cvt_pk_bf16_f32 v193, v162, v163
  v_mfma_f32_32x32x16_bf16 v[128:143], v[54:57], v[244:247], v[128:143]
  ds_read_b128 v[46:49], v18 offset:8192
  v_add_f32 v10, v10, v164
  v_add_f32 v11, v11, v165
  v_cvt_pk_bf16_f32 v194, v164, v165
  v_add_f32 v10, v10, v166
  s_waitcnt lgkmcnt(3)
  v_mfma_f32_32x32x16_bf16 v[128:143], v[58:61], v[248:251], v[128:143]
  ds_read_b128 v[50:53], v19 offset:8192
  v_add_f32 v11, v11, v167
  v_cvt_pk_bf16_f32 v195, v166, v167
  v_add_f32 v10, v10, v168
  v_add_f32 v11, v11, v169
  v_mfma_f32_32x32x16_bf16 v[128:143], v[34:37], v[252:255], v[128:143]
  ds_read_b128 v[54:57], v20 offset:8192
  v_cvt_pk_bf16_f32 v196, v168, v169
  v_add_f32 v10, v10, v170
  v_add_f32 v11, v11, v171
  s_waitcnt lgkmcnt(3)
  v_mfma_f32_32x32x16_bf16 v[144:159], v[38:41], v[224:227], v[208:223]
  ds_read_b128 v[58:61], v21 offset:8192
  v_cvt_pk_bf16_f32 v197, v170, v171
  v_add_f32 v10, v10, v172
  v_add_f32 v11, v11, v173
  v_cvt_pk_bf16_f32 v198, v172, v173
  v_mfma_f32_32x32x16_bf16 v[144:159], v[42:45], v[228:231], v[144:159]
  ds_read_b128 v[34:37], v22 offset:8192
  v_add_f32 v10, v10, v174
  v_add_f32 v11, v11, v175
  v_cvt_pk_bf16_f32 v199, v174, v175
  v_add_f32 v10, v10, v176
  s_waitcnt lgkmcnt(3)
  v_mfma_f32_32x32x16_bf16 v[144:159], v[46:49], v[232:235], v[144:159]
  ds_read_b128 v[38:41], v23 offset:8192
  v_add_f32 v11, v11, v177
  v_cvt_pk_bf16_f32 v200, v176, v177
  v_add_f32 v10, v10, v178
  v_add_f32 v11, v11, v179
  v_mfma_f32_32x32x16_bf16 v[144:159], v[50:53], v[236:239], v[144:159]
  v_cvt_pk_bf16_f32 v201, v178, v179
  v_add_f32 v10, v10, v180
  v_add_f32 v11, v11, v181
  v_cvt_pk_bf16_f32 v202, v180, v181
  s_waitcnt lgkmcnt(2)
  v_mfma_f32_32x32x16_bf16 v[144:159], v[54:57], v[240:243], v[144:159]
  v_add_f32 v10, v10, v182
  v_add_f32 v11, v11, v183
  v_cvt_pk_bf16_f32 v203, v182, v183
  v_add_f32 v10, v10, v184
  v_mfma_f32_32x32x16_bf16 v[144:159], v[58:61], v[244:247], v[144:159]
  v_add_f32 v11, v11, v185
  v_cvt_pk_bf16_f32 v204, v184, v185
  v_add_f32 v10, v10, v186
  v_add_f32 v11, v11, v187
  s_waitcnt lgkmcnt(0)
  v_mfma_f32_32x32x16_bf16 v[144:159], v[34:37], v[248:251], v[144:159]
  v_cvt_pk_bf16_f32 v205, v186, v187
  v_add_f32 v10, v10, v188
  v_add_f32 v11, v11, v189
  v_cvt_pk_bf16_f32 v206, v188, v189
  v_mfma_f32_32x32x16_bf16 v[144:159], v[38:41], v[252:255], v[144:159]
  v_add_f32 v10, v10, v190
  v_add_f32 v11, v11, v191
  v_cvt_pk_bf16_f32 v207, v190, v191
  v_add_u32 v24, 0xffff8000, v24
  v_add_u32 v25, 0xffff8000, v25
  v_add_u32 v26, 0xffff8000, v26
  v_add_u32 v27, 0xffff8000, v27
  s_waitcnt vmcnt(8) lgkmcnt(0)
  s_barrier
  s_cmp_eq_u32 s65, 0
  s_cbranch_scc0 K1_SO2
K1_S2:
  ds_read_b64_tr_b16 v[34:35], v24 offset:0
  ds_read_b64_tr_b16 v[36:37], v24 offset:2048
  ds_read_b64_tr_b16 v[38:39], v25 offset:0
  ds_read_b64_tr_b16 v[40:41], v25 offset:2048
  ds_read_b64_tr_b16 v[42:43], v26 offset:0
  ds_read_b64_tr_b16 v[44:45], v26 offset:2048
  ds_read_b64_tr_b16 v[46:47], v27 offset:0
  ds_read_b64_tr_b16 v[48:49], v27 offset:2048
  ds_read_b64_tr_b16 v[50:51], v24 offset:4096
  ds_read_b64_tr_b16 v[52:53], v24 offset:6144
  s_waitcnt lgkmcnt(6)
  v_mfma_f32_32x32x16_bf16 v[64:79], v[34:37], v[192:195], v[64:79]
  ds_read_b64_tr_b16 v[54:55], v25 offset:4096
  ds_read_b64_tr_b16 v[56:57], v25 offset:6144
  s_add_u32 m0, s61, 147456
  s_add_u32 s58, s75, 4
  s_and_b32 s58, s58, 7
  s_lshl_b32 s58, s58, 14
  s_add_u32 s58, s58, s61
  buffer_load_dwordx4 v28, s[36:39], s58 offen offset:0 nt lds
  buffer_load_dwordx4 v29, s[36:39], s58 offen offset:1024 nt lds
  buffer_load_dwordx4 v30, s[36:39], s58 offen offset:2048 nt lds
  buffer_load_dwordx4 v31, s[36:39], s58 offen offset:3072 nt lds
  v_max3_f32 v8, v128, v129, v130
  v_max3_f32 v9, v144, v145, v146
  v_max3_f32 v8, v8, v131, v132
  v_max3_f32 v9, v9, v147, v148
  v_mfma_f32_32x32x16_bf16 v[80:95], v[38:41], v[192:195], v[80:95]
  ds_read_b64_tr_b16 v[58:59], v26 offset:4096
  ds_read_b64_tr_b16 v[60:61], v26 offset:6144
  v_max3_f32 v8, v8, v133, v134
  v_max3_f32 v9, v9, v149, v150
  v_max3_f32 v8, v8, v135, v136
  v_max3_f32 v9, v9, v151, v152
  s_waitcnt lgkmcnt(6)
  v_mfma_f32_32x32x16_bf16 v[96:111], v[42:45], v[192:195], v[96:111]
  ds_read_b64_tr_b16 v[34:35], v27 offset:4096
  ds_read_b64_tr_b16 v[36:37], v27 offset:6144
  v_max3_f32 v8, v8, v137, v138
  v_max3_f32 v9, v9, v153, v154
  v_max3_f32 v8, v8, v139, v140
  v_max3_f32 v9, v9, v155, v156
  v_mfma_f32_32x32x16_bf16 v[112:127], v[46:49], v[192:195], v[112:127]
  ds_read_b64_tr_b16 v[38:39], v24 offset:8192
  ds_read_b64_tr_b16 v[40:41], v24 offset:10240
  v_max3_f32 v8, v8, v141, v142
  v_max3_f32 v9, v9, v157, v158
  v_max3_f32 v8, v8, v143, v159
  v_max_f32 v8, v8, v9
  s_waitcnt lgkmcnt(6)
  v_mfma_f32_32x32x16_bf16 v[64:79], v[50:53], v[196:199], v[64:79]
  ds_read_b64_tr_b16 v[42:43], v25 offset:8192
  ds_read_b64_tr_b16 v[44:45], v25 offset:10240
  v_mov_b32 v9, v8
  s_nop 1
  v_permlane32_swap_b32 v8, v9
  v_max_f32 v8, v8, v9
  v_cmp_lt_f32 vcc, s64, v8
  s_mov_b32 s65, 0
  s_cmp_lg_u64 vcc, 0
  s_cbranch_scc1 K1_RO2
K1_R2:
  v_mfma_f32_32x32x16_bf16 v[80:95], v[54:57], v[196:199], v[80:95]
  ds_read_b64_tr_b16 v[46:47], v26 offset:8192
  ds_read_b64_tr_b16 v[48:49], v26 offset:10240
  v_exp_f32 v128, v128
  v_exp_f32 v129, v129
  s_waitcnt lgkmcnt(6)
  v_mfma_f32_32x32x16_bf16 v[96:111], v[58:61], v[196:199], v[96:111]
  ds_read_b64_tr_b16 v[50:51], v27 offset:8192
  ds_read_b64_tr_b16 v[52:53], v27 offset:10240
  v_exp_f32 v130, v130
  v_exp_f32 v131, v131
  v_mfma_f32_32x32x16_bf16 v[112:127], v[34:37], v[196:199], v[112:127]
  ds_read_b64_tr_b16 v[54:55], v24 offset:12288
  ds_read_b64_tr_b16 v[56:57], v24 offset:14336
  v_exp_f32 v132, v132
  s_waitcnt lgkmcnt(6)
  v_mfma_f32_32x32x16_bf16 v[64:79], v[38:41], v[200:203], v[64:79]
  ds_read_b64_tr_b16 v[58:59], v25 offset:12288
  ds_read_b64_tr_b16 v[60:61], v25 offset:14336
  v_exp_f32 v133, v133
  v_exp_f32 v134, v134
  v_mfma_f32_32x32x16_bf16 v[80:95], v[42:45], v[200:203], v[80:95]
  ds_read_b64_tr_b16 v[34:35], v26 offset:12288
  ds_read_b64_tr_b16 v[36:37], v26 offset:14336
  v_exp_f32 v135, v135
  v_exp_f32 v136, v136
  s_waitcnt lgkmcnt(6)
  v_mfma_f32_32x32x16_bf16 v[96:111], v[46:49], v[200:203], v[96:111]
  ds_read_b64_tr_b16 v[38:39], v27 offset:12288
  ds_read_b64_tr_b16 v[40:41], v27 offset:14336
  v_exp_f32 v137, v137
  v_mfma_f32_32x32x16_bf16 v[112:127], v[50:53], v[200:203], v[112:127]
  v_exp_f32 v138, v138
  v_exp_f32 v139, v139
  s_waitcnt lgkmcnt(4)
  v_mfma_f32_32x32x16_bf16 v[64:79], v[54:57], v[204:207], v[64:79]
  v_exp_f32 v140, v140
  v_exp_f32 v141, v141
  v_mfma_f32_32x32x16_bf16 v[80:95], v[58:61], v[204:207], v[80:95]
  v_exp_f32 v142, v142
  s_waitcnt lgkmcnt(0)
  v_mfma_f32_32x32x16_bf16 v[96:111], v[34:37], v[204:207], v[96:111]
  v_exp_f32 v143, v143
  v_exp_f32 v144, v144
  v_mfma_f32_32x32x16_bf16 v[112:127], v[38:41], v[204:207], v[112:127]
  v_exp_f32 v145, v145
  v_add_u32 v16, 0xffff8000, v16
  v_add_u32 v17, 0xffff8000, v17
  v_add_u32 v18, 0xffff8000, v18
  v_add_u32 v19, 0xffff8000, v19
  v_add_u32 v20, 0xffff8000, v20
  v_add_u32 v21, 0xffff8000, v21
  v_add_u32 v22, 0xffff8000, v22
  v_add_u32 v23, 0xffff8000, v23
  s_waitcnt vmcnt(8) lgkmcnt(0)
  s_barrier
  ds_read_b128 v[34:37], v16 offset:0
  ds_read_b128 v[38:41], v17 offset:0
  ds_read_b128 v[42:45], v18 offset:0
  ds_read_b128 v[46:49], v19 offset:0
  ds_read_b128 v[50:53], v20 offset:0
  s_waitcnt lgkmcnt(3)
  v_mfma_f32_32x32x16_bf16 v[160:175], v[34:37], v[224:227], v[208:223]
  ds_read_b128 v[54:57], v21 offset:0
  s_add_u32 m0, s61, 98304
  s_add_u32 s58, s75, 3
  s_and_b32 s58, s58, 7
  s_lshl_b32 s58, s58, 14
  s_add_u32 s58, s58, s61
  buffer_load_dwordx4 v32, s[40:43], s58 offen offset:0 nt lds
  buffer_load_dwordx4 v32, s[40:43], s58 offen offset:1024 nt lds
  buffer_load_dwordx4 v32, s[40:43], s58 offen offset:2048 nt lds
  buffer_load_dwordx4 v32, s[40:43], s58 offen offset:3072 nt lds
  v_exp_f32 v146, v146
  v_exp_f32 v147, v147
  v_exp_f32 v148, v148
  v_exp_f32 v149, v149
  v_mfma_f32_32x32x16_bf16 v[160:175], v[38:41], v[228:231], v[160:175]
  ds_read_b128 v[58:61], v22 offset:0
  v_exp_f32 v150, v150
  v_exp_f32 v151, v151
  v_exp_f32 v152, v152
  v_exp_f32 v153, v153
  s_waitcnt lgkmcnt(3)
  v_mfma_f32_32x32x16_bf16 v[160:175], v[42:45], v[232:235], v[160:175]
  ds_read_b128 v[34:37], v23 offset:0
  v_exp_f32 v154, v154
  v_exp_f32 v155, v155
  v_exp_f32 v156, v156
  v_exp_f32 v157, v157
  v_mfma_f32_32x32x16_bf16 v[160:175], v[46:49], v[236:239], v[160:175]
  ds_read_b128 v[38:41], v16 offset:8192
  v_exp_f32 v158, v158
  v_exp_f32 v159, v159
  v_add_f32 v10, v10, v128
  v_add_f32 v11, v11, v129
  s_waitcnt lgkmcnt(3)
  v_mfma_f32_32x32x16_bf16 v[160:175], v[50:53], v[240:243], v[160:175]
  ds_read_b128 v[42:45], v17 offset:8192
  v_cvt_pk_bf16_f32 v192, v128, v129
  v_add_f32 v10, v10, v130
  v_add_f32 v11, v11, v131
  v_cvt_pk_bf16_f32 v193, v130, v131
  v_mfma_f32_32x32x16_bf16 v[160:175], v[54:57], v[244:247], v[160:175]
  ds_read_b128 v[46:49], v18 offset:8192
  v_add_f32 v10, v10, v132
  v_add_f32 v11, v11, v133
  v_cvt_pk_bf16_f32 v194, v132, v133
  v_add_f32 v10, v10, v134
  s_waitcnt lgkmcnt(3)
  v_mfma_f32_32x32x16_bf16 v[160:175], v[58:61], v[248:251], v[160:175]
  ds_read_b128 v[50:53], v19 offset:8192
  v_add_f32 v11, v11, v135
  v_cvt_pk_bf16_f32 v195, v134, v135
  v_add_f32 v10, v10, v136
  v_add_f32 v11, v11, v137
  v_mfma_f32_32x32x16_bf16 v[160:175], v[34:37], v[252:255], v[160:175]
  ds_read_b128 v[54:57], v20 offset:8192
  v_cvt_pk_bf16_f32 v196, v136, v137
  v_add_f32 v10, v10, v138
  v_add_f32 v11, v11, v139
  s_waitcnt lgkmcnt(3)
  v_mfma_f32_32x32x16_bf16 v[176:191], v[38:41], v[224:227], v[208:223]
  ds_read_b128 v[58:61], v21 offset:8192
  v_cvt_pk_bf16_f32 v197, v138, v139
  v_add_f32 v10, v10, v140
  v_add_f32 v11, v11, v141
  v_cvt_pk_bf16_f32 v198, v140, v141
  v_mfma_f32_32x32x16_bf16 v[176:191], v[42:45], v[228:231], v[176:191]
  ds_read_b128 v[34:37], v22 offset:8192
  v_add_f32 v10, v10, v142
  v_add_f32 v11, v11, v143
  v_cvt_pk_bf16_f32 v199, v142, v143
  v_add_f32 v10, v10, v144
  s_waitcnt lgkmcnt(3)
  v_mfma_f32_32x32x16_bf16 v[176:191], v[46:49], v[232:235], v[176:191]
  ds_read_b128 v[38:41], v23 offset:8192
  v_add_f32 v11, v11, v145
  v_cvt_pk_bf16_f32 v200, v144, v145
  v_add_f32 v10, v10, v146
  v_add_f32 v11, v11, v147
  v_mfma_f32_32x32x16_bf16 v[176:191], v[50:53], v[236:239], v[176:191]
  v_cvt_pk_bf16_f32 v201, v146, v147
  v_add_f32 v10, v10, v148
  v_add_f32 v11, v11, v149
  v_cvt_pk_bf16_f32 v202, v148, v149
  s_waitcnt lgkmcnt(2)
  v_mfma_f32_32x32x16_bf16 v[176:191], v[54:57], v[240:243], v[176:191]
  v_add_f32 v10, v10, v150
  v_add_f32 v11, v11, v151
  v_cvt_pk_bf16_f32 v203, v150, v151
  v_add_f32 v10, v10, v152
  v_mfma_f32_32x32x16_bf16 v[176:191], v[58:61], v[244:247], v[176:191]
  v_add_f32 v11, v11, v153
  v_cvt_pk_bf16_f32 v204, v152, v153
  v_add_f32 v10, v10, v154
  v_add_f32 v11, v11, v155
  s_waitcnt lgkmcnt(0)
  v_mfma_f32_32x32x16_bf16 v[176:191], v[34:37], v[248:251], v[176:191]
  v_cvt_pk_bf16_f32 v205, v154, v155
  v_add_f32 v10, v10, v156
  v_add_f32 v11, v11, v157
  v_cvt_pk_bf16_f32 v206, v156, v157
  v_mfma_f32_32x32x16_bf16 v[176:191], v[38:41], v[252:255], v[176:191]
  v_add_f32 v10, v10, v158
  v_add_f32 v11, v11, v159
  v_cvt_pk_bf16_f32 v207, v158, v159
  v_add_u32 v24, 0x8000, v24
  v_add_u32 v25, 0x8000, v25
  v_add_u32 v26, 0x8000, v26
  v_add_u32 v27, 0x8000, v27
  s_waitcnt vmcnt(8) lgkmcnt(0)
  s_barrier
  s_cmp_eq_u32 s65, 0
  s_cbranch_scc0 K1_SO3
K1_S3:
  ds_read_b64_tr_b16 v[34:35], v24 offset:0
  ds_read_b64_tr_b16 v[36:37], v24 offset:2048
  ds_read_b64_tr_b16 v[38:39], v25 offset:0
  ds_read_b64_tr_b16 v[40:41], v25 offset:2048
  ds_read_b64_tr_b16 v[42:43], v26 offset:0
  ds_read_b64_tr_b16 v[44:45], v26 offset:2048
  ds_read_b64_tr_b16 v[46:47], v27 offset:0
  ds_read_b64_tr_b16 v[48:49], v27 offset:2048
  ds_read_b64_tr_b16 v[50:51], v24 offset:4096
  ds_read_b64_tr_b16 v[52:53], v24 offset:6144
  s_waitcnt lgkmcnt(6)
  v_mfma_f32_32x32x16_bf16 v[64:79], v[34:37], v[192:195], v[64:79]
  ds_read_b64_tr_b16 v[54:55], v25 offset:4096
  ds_read_b64_tr_b16 v[56:57], v25 offset:6144
  s_add_u32 m0, s61, 114688
  s_add_u32 s58, s75, 5
  s_and_b32 s58, s58, 7
  s_lshl_b32 s58, s58, 14
  s_add_u32 s58, s58, s61
  buffer_load_dwordx4 v28, s[36:39], s58 offen offset:0 nt lds
  buffer_load_dwordx4 v29, s[36:39], s58 offen offset:1024 nt lds
  buffer_load_dwordx4 v30, s[36:39], s58 offen offset:2048 nt lds
  buffer_load_dwordx4 v31, s[36:39], s58 offen offset:3072 nt lds
  v_max3_f32 v8, v160, v161, v162
  v_max3_f32 v9, v176, v177, v178
  v_max3_f32 v8, v8, v163, v164
  v_max3_f32 v9, v9, v179, v180
  v_mfma_f32_32x32x16_bf16 v[80:95], v[38:41], v[192:195], v[80:95]
  ds_read_b64_tr_b16 v[58:59], v26 offset:4096
  ds_read_b64_tr_b16 v[60:61], v26 offset:6144
  v_max3_f32 v8, v8, v165, v166
  v_max3_f32 v9, v9, v181, v182
  v_max3_f32 v8, v8, v167, v168
  v_max3_f32 v9, v9, v183, v184
  s_waitcnt lgkmcnt(6)
  v_mfma_f32_32x32x16_bf16 v[96:111], v[42:45], v[192:195], v[96:111]
  ds_read_b64_tr_b16 v[34:35], v27 offset:4096
  ds_read_b64_tr_b16 v[36:37], v27 offset:6144
  v_max3_f32 v8, v8, v169, v170
  v_max3_f32 v9, v9, v185, v186
  v_max3_f32 v8, v8, v171, v172
  v_max3_f32 v9, v9, v187, v188
  v_mfma_f32_32x32x16_bf16 v[112:127], v[46:49], v[192:195], v[112:127]
  ds_read_b64_tr_b16 v[38:39], v24 offset:8192
  ds_read_b64_tr_b16 v[40:41], v24 offset:10240
  v_max3_f32 v8, v8, v173, v174
  v_max3_f32 v9, v9, v189, v190
  v_max3_f32 v8, v8, v175, v191
  v_max_f32 v8, v8, v9
  s_waitcnt lgkmcnt(6)
  v_mfma_f32_32x32x16_bf16 v[64:79], v[50:53], v[196:199], v[64:79]
  ds_read_b64_tr_b16 v[42:43], v25 offset:8192
  ds_read_b64_tr_b16 v[44:45], v25 offset:10240
  v_mov_b32 v9, v8
  s_nop 1
  v_permlane32_swap_b32 v8, v9
  v_max_f32 v8, v8, v9
  v_cmp_lt_f32 vcc, s64, v8
  s_mov_b32 s65, 0
  s_cmp_lg_u64 vcc, 0
  s_cbranch_scc1 K1_RO3
K1_R3:
  v_mfma_f32_32x32x16_bf16 v[80:95], v[54:57], v[196:199], v[80:95]
  ds_read_b64_tr_b16 v[46:47], v26 offset:8192
  ds_read_b64_tr_b16 v[48:49], v26 offset:10240
  v_exp_f32 v160, v160
  v_exp_f32 v161, v161
  s_waitcnt lgkmcnt(6)
  v_mfma_f32_32x32x16_bf16 v[96:111], v[58:61], v[196:199], v[96:111]
  ds_read_b64_tr_b16 v[50:51], v27 offset:8192
  ds_read_b64_tr_b16 v[52:53], v27 offset:10240
  v_exp_f32 v162, v162
  v_exp_f32 v163, v163
  v_mfma_f32_32x32x16_bf16 v[112:127], v[34:37], v[196:199], v[112:127]
  ds_read_b64_tr_b16 v[54:55], v24 offset:12288
  ds_read_b64_tr_b16 v[56:57], v24 offset:14336
  v_exp_f32 v164, v164
  s_waitcnt lgkmcnt(6)
  v_mfma_f32_32x32x16_bf16 v[64:79], v[38:41], v[200:203], v[64:79]
  ds_read_b64_tr_b16 v[58:59], v25 offset:12288
  ds_read_b64_tr_b16 v[60:61], v25 offset:14336
  v_exp_f32 v165, v165
  v_exp_f32 v166, v166
  v_mfma_f32_32x32x16_bf16 v[80:95], v[42:45], v[200:203], v[80:95]
  ds_read_b64_tr_b16 v[34:35], v26 offset:12288
  ds_read_b64_tr_b16 v[36:37], v26 offset:14336
  v_exp_f32 v167, v167
  v_exp_f32 v168, v168
  s_waitcnt lgkmcnt(6)
  v_mfma_f32_32x32x16_bf16 v[96:111], v[46:49], v[200:203], v[96:111]
  ds_read_b64_tr_b16 v[38:39], v27 offset:12288
  ds_read_b64_tr_b16 v[40:41], v27 offset:14336
  v_exp_f32 v169, v169
  v_mfma_f32_32x32x16_bf16 v[112:127], v[50:53], v[200:203], v[112:127]
  v_exp_f32 v170, v170
  v_exp_f32 v171, v171
  s_waitcnt lgkmcnt(4)
  v_mfma_f32_32x32x16_bf16 v[64:79], v[54:57], v[204:207], v[64:79]
  v_exp_f32 v172, v172
  v_exp_f32 v173, v173
  v_mfma_f32_32x32x16_bf16 v[80:95], v[58:61], v[204:207], v[80:95]
  v_exp_f32 v174, v174
  s_waitcnt lgkmcnt(0)
  v_mfma_f32_32x32x16_bf16 v[96:111], v[34:37], v[204:207], v[96:111]
  v_exp_f32 v175, v175
  v_exp_f32 v176, v176
  v_mfma_f32_32x32x16_bf16 v[112:127], v[38:41], v[204:207], v[112:127]
  v_exp_f32 v177, v177
  v_add_u32 v16, 0x8000, v16
  v_add_u32 v17, 0x8000, v17
  v_add_u32 v18, 0x8000, v18
  v_add_u32 v19, 0x8000, v19
  v_add_u32 v20, 0x8000, v20
  v_add_u32 v21, 0x8000, v21
  v_add_u32 v22, 0x8000, v22
  v_add_u32 v23, 0x8000, v23
  s_waitcnt vmcnt(8) lgkmcnt(0)
  s_barrier
  ds_read_b128 v[34:37], v16 offset:0
  ds_read_b128 v[38:41], v17 offset:0
  ds_read_b128 v[42:45], v18 offset:0
  ds_read_b128 v[46:49], v19 offset:0
  ds_read_b128 v[50:53], v20 offset:0
  s_waitcnt lgkmcnt(3)
  v_mfma_f32_32x32x16_bf16 v[128:143], v[34:37], v[224:227], v[208:223]
  ds_read_b128 v[54:57], v21 offset:0
  s_add_u32 m0, s61, 131072
  s_add_u32 s58, s75, 4
  s_and_b32 s58, s58, 7
  s_lshl_b32 s58, s58, 14
  s_add_u32 s58, s58, s61
  buffer_load_dwordx4 v32, s[40:43], s58 offen offset:0 nt lds
  buffer_load_dwordx4 v32, s[40:43], s58 offen offset:1024 nt lds
  buffer_load_dwordx4 v32, s[40:43], s58 offen offset:2048 nt lds
  buffer_load_dwordx4 v32, s[40:43], s58 offen offset:3072 nt lds
  v_exp_f32 v178, v178
  v_exp_f32 v179, v179
  v_exp_f32 v180, v180
  v_exp_f32 v181, v181
  v_mfma_f32_32x32x16_bf16 v[128:143], v[38:41], v[228:231], v[128:143]
  ds_read_b128 v[58:61], v22 offset:0
  v_exp_f32 v182, v182
  v_exp_f32 v183, v183
  v_exp_f32 v184, v184
  v_exp_f32 v185, v185
  s_waitcnt lgkmcnt(3)
  v_mfma_f32_32x32x16_bf16 v[128:143], v[42:45], v[232:235], v[128:143]
  ds_read_b128 v[34:37], v23 offset:0
  v_exp_f32 v186, v186
  v_exp_f32 v187, v187
  v_exp_f32 v188, v188
  v_exp_f32 v189, v189
  v_mfma_f32_32x32x16_bf16 v[128:143], v[46:49], v[236:239], v[128:143]
  ds_read_b128 v[38:41], v16 offset:8192
  v_exp_f32 v190, v190
  v_exp_f32 v191, v191
  v_add_f32 v10, v10, v160
  v_add_f32 v11, v11, v161
  s_waitcnt lgkmcnt(3)
  v_mfma_f32_32x32x16_bf16 v[128:143], v[50:53], v[240:243], v[128:143]
  ds_read_b128 v[42:45], v17 offset:8192
  v_cvt_pk_bf16_f32 v192, v160, v161
  v_add_f32 v10, v10, v162
  v_add_f32 v11, v11, v163
  v_cvt_pk_bf16_f32 v193, v162, v163
  v_mfma_f32_32x32x16_bf16 v[128:143], v[54:57], v[244:247], v[128:143]
  ds_read_b128 v[46:49], v18 offset:8192
  v_add_f32 v10, v10, v164
  v_add_f32 v11, v11, v165
  v_cvt_pk_bf16_f32 v194, v164, v165
  v_add_f32 v10, v10, v166
  s_waitcnt lgkmcnt(3)
  v_mfma_f32_32x32x16_bf16 v[128:143], v[58:61], v[248:251], v[128:143]
  ds_read_b128 v[50:53], v19 offset:8192
  v_add_f32 v11, v11, v167
  v_cvt_pk_bf16_f32 v195, v166, v167
  v_add_f32 v10, v10, v168
  v_add_f32 v11, v11, v169
  v_mfma_f32_32x32x16_bf16 v[128:143], v[34:37], v[252:255], v[128:143]
  ds_read_b128 v[54:57], v20 offset:8192
  v_cvt_pk_bf16_f32 v196, v168, v169
  v_add_f32 v10, v10, v170
  v_add_f32 v11, v11, v171
  s_waitcnt lgkmcnt(3)
  v_mfma_f32_32x32x16_bf16 v[144:159], v[38:41], v[224:227], v[208:223]
  ds_read_b128 v[58:61], v21 offset:8192
  v_cvt_pk_bf16_f32 v197, v170, v171
  v_add_f32 v10, v10, v172
  v_add_f32 v11, v11, v173
  v_cvt_pk_bf16_f32 v198, v172, v173
  v_mfma_f32_32x32x16_bf16 v[144:159], v[42:45], v[228:231], v[144:159]
  ds_read_b128 v[34:37], v22 offset:8192
  v_add_f32 v10, v10, v174
  v_add_f32 v11, v11, v175
  v_cvt_pk_bf16_f32 v199, v174, v175
  v_add_f32 v10, v10, v176
  s_waitcnt lgkmcnt(3)
  v_mfma_f32_32x32x16_bf16 v[144:159], v[46:49], v[232:235], v[144:159]
  ds_read_b128 v[38:41], v23 offset:8192
  v_add_f32 v11, v11, v177
  v_cvt_pk_bf16_f32 v200, v176, v177
  v_add_f32 v10, v10, v178
  v_add_f32 v11, v11, v179
  v_mfma_f32_32x32x16_bf16 v[144:159], v[50:53], v[236:239], v[144:159]
  v_cvt_pk_bf16_f32 v201, v178, v179
  v_add_f32 v10, v10, v180
  v_add_f32 v11, v11, v181
  v_cvt_pk_bf16_f32 v202, v180, v181
  s_waitcnt lgkmcnt(2)
  v_mfma_f32_32x32x16_bf16 v[144:159], v[54:57], v[240:243], v[144:159]
  v_add_f32 v10, v10, v182
  v_add_f32 v11, v11, v183
  v_cvt_pk_bf16_f32 v203, v182, v183
  v_add_f32 v10, v10, v184
  v_mfma_f32_32x32x16_bf16 v[144:159], v[58:61], v[244:247], v[144:159]
  v_add_f32 v11, v11, v185
  v_cvt_pk_bf16_f32 v204, v184, v185
  v_add_f32 v10, v10, v186
  v_add_f32 v11, v11, v187
  s_waitcnt lgkmcnt(0)
  v_mfma_f32_32x32x16_bf16 v[144:159], v[34:37], v[248:251], v[144:159]
  v_cvt_pk_bf16_f32 v205, v186, v187
  v_add_f32 v10, v10, v188
  v_add_f32 v11, v11, v189
  v_cvt_pk_bf16_f32 v206, v188, v189
  v_mfma_f32_32x32x16_bf16 v[144:159], v[38:41], v[252:255], v[144:159]
  v_add_f32 v10, v10, v190
  v_add_f32 v11, v11, v191
  v_cvt_pk_bf16_f32 v207, v190, v191
  v_add_u32 v24, 0xffff8000, v24
  v_add_u32 v25, 0xffff8000, v25
  v_add_u32 v26, 0xffff8000, v26
  v_add_u32 v27, 0xffff8000, v27
  s_waitcnt vmcnt(8) lgkmcnt(0)
  s_barrier
  s_cmp_eq_u32 s65, 0
  s_cbranch_scc0 K1_SO4
K1_S4:
  ds_read_b64_tr_b16 v[34:35], v24 offset:0
  ds_read_b64_tr_b16 v[36:37], v24 offset:2048
  ds_read_b64_tr_b16 v[38:39], v25 offset:0
  ds_read_b64_tr_b16 v[40:41], v25 offset:2048
  ds_read_b64_tr_b16 v[42:43], v26 offset:0
  ds_read_b64_tr_b16 v[44:45], v26 offset:2048
  ds_read_b64_tr_b16 v[46:47], v27 offset:0
  ds_read_b64_tr_b16 v[48:49], v27 offset:2048
  ds_read_b64_tr_b16 v[50:51], v24 offset:4096
  ds_read_b64_tr_b16 v[52:53], v24 offset:6144
  s_waitcnt lgkmcnt(6)
  v_mfma_f32_32x32x16_bf16 v[64:79], v[34:37], v[192:195], v[64:79]
  ds_read_b64_tr_b16 v[54:55], v25 offset:4096
  ds_read_b64_tr_b16 v[56:57], v25 offset:6144
  s_add_u32 m0, s61, 147456
  s_add_u32 s58, s75, 6
  s_and_b32 s58, s58, 7
  s_lshl_b32 s58, s58, 14
  s_add_u32 s58, s58, s61
  buffer_load_dwordx4 v28, s[36:39], s58 offen offset:0 nt lds
  buffer_load_dwordx4 v29, s[36:39], s58 offen offset:1024 nt lds
  buffer_load_dwordx4 v30, s[36:39], s58 offen offset:2048 nt lds
  buffer_load_dwordx4 v31, s[36:39], s58 offen offset:3072 nt lds
  v_max3_f32 v8, v128, v129, v130
  v_max3_f32 v9, v144, v145, v146
  v_max3_f32 v8, v8, v131, v132
  v_max3_f32 v9, v9, v147, v148
  v_mfma_f32_32x32x16_bf16 v[80:95], v[38:41], v[192:195], v[80:95]
  ds_read_b64_tr_b16 v[58:59], v26 offset:4096
  ds_read_b64_tr_b16 v[60:61], v26 offset:6144
  v_max3_f32 v8, v8, v133, v134
  v_max3_f32 v9, v9, v149, v150
  v_max3_f32 v8, v8, v135, v136
  v_max3_f32 v9, v9, v151, v152
  s_waitcnt lgkmcnt(6)
  v_mfma_f32_32x32x16_bf16 v[96:111], v[42:45], v[192:195], v[96:111]
  ds_read_b64_tr_b16 v[34:35], v27 offset:4096
  ds_read_b64_tr_b16 v[36:37], v27 offset:6144
  v_max3_f32 v8, v8, v137, v138
  v_max3_f32 v9, v9, v153, v154
  v_max3_f32 v8, v8, v139, v140
  v_max3_f32 v9, v9, v155, v156
  v_mfma_f32_32x32x16_bf16 v[112:127], v[46:49], v[192:195], v[112:127]
  ds_read_b64_tr_b16 v[38:39], v24 offset:8192
  ds_read_b64_tr_b16 v[40:41], v24 offset:10240
  v_max3_f32 v8, v8, v141, v142
  v_max3_f32 v9, v9, v157, v158
  v_max3_f32 v8, v8, v143, v159
  v_max_f32 v8, v8, v9
  s_waitcnt lgkmcnt(6)
  v_mfma_f32_32x32x16_bf16 v[64:79], v[50:53], v[196:199], v[64:79]
  ds_read_b64_tr_b16 v[42:43], v25 offset:8192
  ds_read_b64_tr_b16 v[44:45], v25 offset:10240
  v_mov_b32 v9, v8
  s_nop 1
  v_permlane32_swap_b32 v8, v9
  v_max_f32 v8, v8, v9
  v_cmp_lt_f32 vcc, s64, v8
  s_mov_b32 s65, 0
  s_cmp_lg_u64 vcc, 0
  s_cbranch_scc1 K1_RO4
K1_R4:
  v_mfma_f32_32x32x16_bf16 v[80:95], v[54:57], v[196:199], v[80:95]
  ds_read_b64_tr_b16 v[46:47], v26 offset:8192
  ds_read_b64_tr_b16 v[48:49], v26 offset:10240
  v_exp_f32 v128, v128
  v_exp_f32 v129, v129
  s_waitcnt lgkmcnt(6)
  v_mfma_f32_32x32x16_bf16 v[96:111], v[58:61], v[196:199], v[96:111]
  ds_read_b64_tr_b16 v[50:51], v27 offset:8192
  ds_read_b64_tr_b16 v[52:53], v27 offset:10240
  v_exp_f32 v130, v130
  v_exp_f32 v131, v131
  v_mfma_f32_32x32x16_bf16 v[112:127], v[34:37], v[196:199], v[112:127]
  ds_read_b64_tr_b16 v[54:55], v24 offset:12288
  ds_read_b64_tr_b16 v[56:57], v24 offset:14336
  v_exp_f32 v132, v132
  s_waitcnt lgkmcnt(6)
  v_mfma_f32_32x32x16_bf16 v[64:79], v[38:41], v[200:203], v[64:79]
  ds_read_b64_tr_b16 v[58:59], v25 offset:12288
  ds_read_b64_tr_b16 v[60:61], v25 offset:14336
  v_exp_f32 v133, v133
  v_exp_f32 v134, v134
  v_mfma_f32_32x32x16_bf16 v[80:95], v[42:45], v[200:203], v[80:95]
  ds_read_b64_tr_b16 v[34:35], v26 offset:12288
  ds_read_b64_tr_b16 v[36:37], v26 offset:14336
  v_exp_f32 v135, v135
  v_exp_f32 v136, v136
  s_waitcnt lgkmcnt(6)
  v_mfma_f32_32x32x16_bf16 v[96:111], v[46:49], v[200:203], v[96:111]
  ds_read_b64_tr_b16 v[38:39], v27 offset:12288
  ds_read_b64_tr_b16 v[40:41], v27 offset:14336
  v_exp_f32 v137, v137
  v_mfma_f32_32x32x16_bf16 v[112:127], v[50:53], v[200:203], v[112:127]
  v_exp_f32 v138, v138
  v_exp_f32 v139, v139
  s_waitcnt lgkmcnt(4)
  v_mfma_f32_32x32x16_bf16 v[64:79], v[54:57], v[204:207], v[64:79]
  v_exp_f32 v140, v140
  v_exp_f32 v141, v141
  v_mfma_f32_32x32x16_bf16 v[80:95], v[58:61], v[204:207], v[80:95]
  v_exp_f32 v142, v142
  s_waitcnt lgkmcnt(0)
  v_mfma_f32_32x32x16_bf16 v[96:111], v[34:37], v[204:207], v[96:111]
  v_exp_f32 v143, v143
  v_exp_f32 v144, v144
  v_mfma_f32_32x32x16_bf16 v[112:127], v[38:41], v[204:207], v[112:127]
  v_exp_f32 v145, v145
  v_add_u32 v16, 0xffff8000, v16
  v_add_u32 v17, 0xffff8000, v17
  v_add_u32 v18, 0xffff8000, v18
  v_add_u32 v19, 0xffff8000, v19
  v_add_u32 v20, 0xffff8000, v20
  v_add_u32 v21, 0xffff8000, v21
  v_add_u32 v22, 0xffff8000, v22
  v_add_u32 v23, 0xffff8000, v23
  s_waitcnt vmcnt(8) lgkmcnt(0)
  s_barrier
  ds_read_b128 v[34:37], v16 offset:0
  ds_read_b128 v[38:41], v17 offset:0
  ds_read_b128 v[42:45], v18 offset:0
  ds_read_b128 v[46:49], v19 offset:0
  ds_read_b128 v[50:53], v20 offset:0
  s_waitcnt lgkmcnt(3)
  v_mfma_f32_32x32x16_bf16 v[160:175], v[34:37], v[224:227], v[208:223]
  ds_read_b128 v[54:57], v21 offset:0
  s_add_u32 m0, s61, 98304
  s_add_u32 s58, s75, 5
  s_and_b32 s58, s58, 7
  s_lshl_b32 s58, s58, 14
  s_add_u32 s58, s58, s61
  buffer_load_dwordx4 v32, s[40:43], s58 offen offset:0 nt lds
  buffer_load_dwordx4 v32, s[40:43], s58 offen offset:1024 nt lds
  buffer_load_dwordx4 v32, s[40:43], s58 offen offset:2048 nt lds
  buffer_load_dwordx4 v32, s[40:43], s58 offen offset:3072 nt lds
  v_exp_f32 v146, v146
  v_exp_f32 v147, v147
  v_exp_f32 v148, v148
  v_exp_f32 v149, v149
  v_mfma_f32_32x32x16_bf16 v[160:175], v[38:41], v[228:231], v[160:175]
  ds_read_b128 v[58:61], v22 offset:0
  v_exp_f32 v150, v150
  v_exp_f32 v151, v151
  v_exp_f32 v152, v152
  v_exp_f32 v153, v153
  s_waitcnt lgkmcnt(3)
  v_mfma_f32_32x32x16_bf16 v[160:175], v[42:45], v[232:235], v[160:175]
  ds_read_b128 v[34:37], v23 offset:0
  v_exp_f32 v154, v154
  v_exp_f32 v155, v155
  v_exp_f32 v156, v156
  v_exp_f32 v157, v157
  v_mfma_f32_32x32x16_bf16 v[160:175], v[46:49], v[236:239], v[160:175]
  ds_read_b128 v[38:41], v16 offset:8192
  v_exp_f32 v158, v158
  v_exp_f32 v159, v159
  v_add_f32 v10, v10, v128
  v_add_f32 v11, v11, v129
  s_waitcnt lgkmcnt(3)
  v_mfma_f32_32x32x16_bf16 v[160:175], v[50:53], v[240:243], v[160:175]
  ds_read_b128 v[42:45], v17 offset:8192
  v_cvt_pk_bf16_f32 v192, v128, v129
  v_add_f32 v10, v10, v130
  v_add_f32 v11, v11, v131
  v_cvt_pk_bf16_f32 v193, v130, v131
  v_mfma_f32_32x32x16_bf16 v[160:175], v[54:57], v[244:247], v[160:175]
  ds_read_b128 v[46:49], v18 offset:8192
  v_add_f32 v10, v10, v132
  v_add_f32 v11, v11, v133
  v_cvt_pk_bf16_f32 v194, v132, v133
  v_add_f32 v10, v10, v134
  s_waitcnt lgkmcnt(3)
  v_mfma_f32_32x32x16_bf16 v[160:175], v[58:61], v[248:251], v[160:175]
  ds_read_b128 v[50:53], v19 offset:8192
  v_add_f32 v11, v11, v135
  v_cvt_pk_bf16_f32 v195, v134, v135
  v_add_f32 v10, v10, v136
  v_add_f32 v11, v11, v137
  v_mfma_f32_32x32x16_bf16 v[160:175], v[34:37], v[252:255], v[160:175]
  ds_read_b128 v[54:57], v20 offset:8192
  v_cvt_pk_bf16_f32 v196, v136, v137
  v_add_f32 v10, v10, v138
  v_add_f32 v11, v11, v139
  s_waitcnt lgkmcnt(3)
  v_mfma_f32_32x32x16_bf16 v[176:191], v[38:41], v[224:227], v[208:223]
  ds_read_b128 v[58:61], v21 offset:8192
  v_cvt_pk_bf16_f32 v197, v138, v139
  v_add_f32 v10, v10, v140
  v_add_f32 v11, v11, v141
  v_cvt_pk_bf16_f32 v198, v140, v141
  v_mfma_f32_32x32x16_bf16 v[176:191], v[42:45], v[228:231], v[176:191]
  ds_read_b128 v[34:37], v22 offset:8192
  v_add_f32 v10, v10, v142
  v_add_f32 v11, v11, v143
  v_cvt_pk_bf16_f32 v199, v142, v143
  v_add_f32 v10, v10, v144
  s_waitcnt lgkmcnt(3)
  v_mfma_f32_32x32x16_bf16 v[176:191], v[46:49], v[232:235], v[176:191]
  ds_read_b128 v[38:41], v23 offset:8192
  v_add_f32 v11, v11, v145
  v_cvt_pk_bf16_f32 v200, v144, v145
  v_add_f32 v10, v10, v146
  v_add_f32 v11, v11, v147
  v_mfma_f32_32x32x16_bf16 v[176:191], v[50:53], v[236:239], v[176:191]
  v_cvt_pk_bf16_f32 v201, v146, v147
  v_add_f32 v10, v10, v148
  v_add_f32 v11, v11, v149
  v_cvt_pk_bf16_f32 v202, v148, v149
  s_waitcnt lgkmcnt(2)
  v_mfma_f32_32x32x16_bf16 v[176:191], v[54:57], v[240:243], v[176:191]
  v_add_f32 v10, v10, v150
  v_add_f32 v11, v11, v151
  v_cvt_pk_bf16_f32 v203, v150, v151
  v_add_f32 v10, v10, v152
  v_mfma_f32_32x32x16_bf16 v[176:191], v[58:61], v[244:247], v[176:191]
  v_add_f32 v11, v11, v153
  v_cvt_pk_bf16_f32 v204, v152, v153
  v_add_f32 v10, v10, v154
  v_add_f32 v11, v11, v155
  s_waitcnt lgkmcnt(0)
  v_mfma_f32_32x32x16_bf16 v[176:191], v[34:37], v[248:251], v[176:191]
  v_cvt_pk_bf16_f32 v205, v154, v155
  v_add_f32 v10, v10, v156
  v_add_f32 v11, v11, v157
  v_cvt_pk_bf16_f32 v206, v156, v157
  v_mfma_f32_32x32x16_bf16 v[176:191], v[38:41], v[252:255], v[176:191]
  v_add_f32 v10, v10, v158
  v_add_f32 v11, v11, v159
  v_cvt_pk_bf16_f32 v207, v158, v159
  v_add_u32 v24, 0x8000, v24
  v_add_u32 v25, 0x8000, v25
  v_add_u32 v26, 0x8000, v26
  v_add_u32 v27, 0x8000, v27
  s_waitcnt vmcnt(8) lgkmcnt(0)
  s_barrier
  s_cmp_eq_u32 s65, 0
  s_cbranch_scc0 K1_SO5
K1_S5:
  ds_read_b64_tr_b16 v[34:35], v24 offset:0
  ds_read_b64_tr_b16 v[36:37], v24 offset:2048
  ds_read_b64_tr_b16 v[38:39], v25 offset:0
  ds_read_b64_tr_b16 v[40:41], v25 offset:2048
  ds_read_b64_tr_b16 v[42:43], v26 offset:0
  ds_read_b64_tr_b16 v[44:45], v26 offset:2048
  ds_read_b64_tr_b16 v[46:47], v27 offset:0
  ds_read_b64_tr_b16 v[48:49], v27 offset:2048
  ds_read_b64_tr_b16 v[50:51], v24 offset:4096
  ds_read_b64_tr_b16 v[52:53], v24 offset:6144
  s_waitcnt lgkmcnt(6)
  v_mfma_f32_32x32x16_bf16 v[64:79], v[34:37], v[192:195], v[64:79]
  ds_read_b64_tr_b16 v[54:55], v25 offset:4096
  ds_read_b64_tr_b16 v[56:57], v25 offset:6144
  s_add_u32 m0, s61, 114688
  s_add_u32 s58, s75, 7
  s_and_b32 s58, s58, 7
  s_lshl_b32 s58, s58, 14
  s_add_u32 s58, s58, s61
  buffer_load_dwordx4 v28, s[36:39], s58 offen offset:0 nt lds
  buffer_load_dwordx4 v29, s[36:39], s58 offen offset:1024 nt lds
  buffer_load_dwordx4 v30, s[36:39], s58 offen offset:2048 nt lds
  buffer_load_dwordx4 v31, s[36:39], s58 offen offset:3072 nt lds
  v_max3_f32 v8, v160, v161, v162
  v_max3_f32 v9, v176, v177, v178
  v_max3_f32 v8, v8, v163, v164
  v_max3_f32 v9, v9, v179, v180
  v_mfma_f32_32x32x16_bf16 v[80:95], v[38:41], v[192:195], v[80:95]
  ds_read_b64_tr_b16 v[58:59], v26 offset:4096
  ds_read_b64_tr_b16 v[60:61], v26 offset:6144
  v_max3_f32 v8, v8, v165, v166
  v_max3_f32 v9, v9, v181, v182
  v_max3_f32 v8, v8, v167, v168
  v_max3_f32 v9, v9, v183, v184
  s_waitcnt lgkmcnt(6)
  v_mfma_f32_32x32x16_bf16 v[96:111], v[42:45], v[192:195], v[96:111]
  ds_read_b64_tr_b16 v[34:35], v27 offset:4096
  ds_read_b64_tr_b16 v[36:37], v27 offset:6144
  v_max3_f32 v8, v8, v169, v170
  v_max3_f32 v9, v9, v185, v186
  v_max3_f32 v8, v8, v171, v172
  v_max3_f32 v9, v9, v187, v188
  v_mfma_f32_32x32x16_bf16 v[112:127], v[46:49], v[192:195], v[112:127]
  ds_read_b64_tr_b16 v[38:39], v24 offset:8192
  ds_read_b64_tr_b16 v[40:41], v24 offset:10240
  v_max3_f32 v8, v8, v173, v174
  v_max3_f32 v9, v9, v189, v190
  v_max3_f32 v8, v8, v175, v191
  v_max_f32 v8, v8, v9
  s_waitcnt lgkmcnt(6)
  v_mfma_f32_32x32x16_bf16 v[64:79], v[50:53], v[196:199], v[64:79]
  ds_read_b64_tr_b16 v[42:43], v25 offset:8192
  ds_read_b64_tr_b16 v[44:45], v25 offset:10240
  v_mov_b32 v9, v8
  s_nop 1
  v_permlane32_swap_b32 v8, v9
  v_max_f32 v8, v8, v9
  v_cmp_lt_f32 vcc, s64, v8
  s_mov_b32 s65, 0
  s_cmp_lg_u64 vcc, 0
  s_cbranch_scc1 K1_RO5
K1_R5:
  v_mfma_f32_32x32x16_bf16 v[80:95], v[54:57], v[196:199], v[80:95]
  ds_read_b64_tr_b16 v[46:47], v26 offset:8192
  ds_read_b64_tr_b16 v[48:49], v26 offset:10240
  v_exp_f32 v160, v160
  v_exp_f32 v161, v161
  s_waitcnt lgkmcnt(6)
  v_mfma_f32_32x32x16_bf16 v[96:111], v[58:61], v[196:199], v[96:111]
  ds_read_b64_tr_b16 v[50:51], v27 offset:8192
  ds_read_b64_tr_b16 v[52:53], v27 offset:10240
  v_exp_f32 v162, v162
  v_exp_f32 v163, v163
  v_mfma_f32_32x32x16_bf16 v[112:127], v[34:37], v[196:199], v[112:127]
  ds_read_b64_tr_b16 v[54:55], v24 offset:12288
  ds_read_b64_tr_b16 v[56:57], v24 offset:14336
  v_exp_f32 v164, v164
  s_waitcnt lgkmcnt(6)
  v_mfma_f32_32x32x16_bf16 v[64:79], v[38:41], v[200:203], v[64:79]
  ds_read_b64_tr_b16 v[58:59], v25 offset:12288
  ds_read_b64_tr_b16 v[60:61], v25 offset:14336
  v_exp_f32 v165, v165
  v_exp_f32 v166, v166
  v_mfma_f32_32x32x16_bf16 v[80:95], v[42:45], v[200:203], v[80:95]
  ds_read_b64_tr_b16 v[34:35], v26 offset:12288
  ds_read_b64_tr_b16 v[36:37], v26 offset:14336
  v_exp_f32 v167, v167
  v_exp_f32 v168, v168
  s_waitcnt lgkmcnt(6)
  v_mfma_f32_32x32x16_bf16 v[96:111], v[46:49], v[200:203], v[96:111]
  ds_read_b64_tr_b16 v[38:39], v27 offset:12288
  ds_read_b64_tr_b16 v[40:41], v27 offset:14336
  v_exp_f32 v169, v169
  v_mfma_f32_32x32x16_bf16 v[112:127], v[50:53], v[200:203], v[112:127]
  v_exp_f32 v170, v170
  v_exp_f32 v171, v171
  s_waitcnt lgkmcnt(4)
  v_mfma_f32_32x32x16_bf16 v[64:79], v[54:57], v[204:207], v[64:79]
  v_exp_f32 v172, v172
  v_exp_f32 v173, v173
  v_mfma_f32_32x32x16_bf16 v[80:95], v[58:61], v[204:207], v[80:95]
  v_exp_f32 v174, v174
  s_waitcnt lgkmcnt(0)
  v_mfma_f32_32x32x16_bf16 v[96:111], v[34:37], v[204:207], v[96:111]
  v_exp_f32 v175, v175
  v_exp_f32 v176, v176
  v_mfma_f32_32x32x16_bf16 v[112:127], v[38:41], v[204:207], v[112:127]
  v_exp_f32 v177, v177
  v_add_u32 v16, 0x8000, v16
  v_add_u32 v17, 0x8000, v17
  v_add_u32 v18, 0x8000, v18
  v_add_u32 v19, 0x8000, v19
  v_add_u32 v20, 0x8000, v20
  v_add_u32 v21, 0x8000, v21
  v_add_u32 v22, 0x8000, v22
  v_add_u32 v23, 0x8000, v23
  s_waitcnt vmcnt(8) lgkmcnt(0)
  s_barrier
  ds_read_b128 v[34:37], v16 offset:0
  ds_read_b128 v[38:41], v17 offset:0
  ds_read_b128 v[42:45], v18 offset:0
  ds_read_b128 v[46:49], v19 offset:0
  ds_read_b128 v[50:53], v20 offset:0
  s_waitcnt lgkmcnt(3)
  v_mfma_f32_32x32x16_bf16 v[128:143], v[34:37], v[224:227], v[208:223]
  ds_read_b128 v[54:57], v21 offset:0
  s_add_u32 m0, s61, 131072
  s_add_u32 s58, s75, 6
  s_and_b32 s58, s58, 7
  s_lshl_b32 s58, s58, 14
  s_add_u32 s58, s58, s61
  buffer_load_dwordx4 v32, s[40:43], s58 offen offset:0 nt lds
  buffer_load_dwordx4 v32, s[40:43], s58 offen offset:1024 nt lds
  buffer_load_dwordx4 v32, s[40:43], s58 offen offset:2048 nt lds
  buffer_load_dwordx4 v32, s[40:43], s58 offen offset:3072 nt lds
  v_exp_f32 v178, v178
  v_exp_f32 v179, v179
  v_exp_f32 v180, v180
  v_exp_f32 v181, v181
  v_mfma_f32_32x32x16_bf16 v[128:143], v[38:41], v[228:231], v[128:143]
  ds_read_b128 v[58:61], v22 offset:0
  v_exp_f32 v182, v182
  v_exp_f32 v183, v183
  v_exp_f32 v184, v184
  v_exp_f32 v185, v185
  s_waitcnt lgkmcnt(3)
  v_mfma_f32_32x32x16_bf16 v[128:143], v[42:45], v[232:235], v[128:143]
  ds_read_b128 v[34:37], v23 offset:0
  v_exp_f32 v186, v186
  v_exp_f32 v187, v187
  v_exp_f32 v188, v188
  v_exp_f32 v189, v189
  v_mfma_f32_32x32x16_bf16 v[128:143], v[46:49], v[236:239], v[128:143]
  ds_read_b128 v[38:41], v16 offset:8192
  v_exp_f32 v190, v190
  v_exp_f32 v191, v191
  v_add_f32 v10, v10, v160
  v_add_f32 v11, v11, v161
  s_waitcnt lgkmcnt(3)
  v_mfma_f32_32x32x16_bf16 v[128:143], v[50:53], v[240:243], v[128:143]
  ds_read_b128 v[42:45], v17 offset:8192
  v_cvt_pk_bf16_f32 v192, v160, v161
  v_add_f32 v10, v10, v162
  v_add_f32 v11, v11, v163
  v_cvt_pk_bf16_f32 v193, v162, v163
  v_mfma_f32_32x32x16_bf16 v[128:143], v[54:57], v[244:247], v[128:143]
  ds_read_b128 v[46:49], v18 offset:8192
  v_add_f32 v10, v10, v164
  v_add_f32 v11, v11, v165
  v_cvt_pk_bf16_f32 v194, v164, v165
  v_add_f32 v10, v10, v166
  s_waitcnt lgkmcnt(3)
  v_mfma_f32_32x32x16_bf16 v[128:143], v[58:61], v[248:251], v[128:143]
  ds_read_b128 v[50:53], v19 offset:8192
  v_add_f32 v11, v11, v167
  v_cvt_pk_bf16_f32 v195, v166, v167
  v_add_f32 v10, v10, v168
  v_add_f32 v11, v11, v169
  v_mfma_f32_32x32x16_bf16 v[128:143], v[34:37], v[252:255], v[128:143]
  ds_read_b128 v[54:57], v20 offset:8192
  v_cvt_pk_bf16_f32 v196, v168, v169
  v_add_f32 v10, v10, v170
  v_add_f32 v11, v11, v171
  s_waitcnt lgkmcnt(3)
  v_mfma_f32_32x32x16_bf16 v[144:159], v[38:41], v[224:227], v[208:223]
  ds_read_b128 v[58:61], v21 offset:8192
  v_cvt_pk_bf16_f32 v197, v170, v171
  v_add_f32 v10, v10, v172
  v_add_f32 v11, v11, v173
  v_cvt_pk_bf16_f32 v198, v172, v173
  v_mfma_f32_32x32x16_bf16 v[144:159], v[42:45], v[228:231], v[144:159]
  ds_read_b128 v[34:37], v22 offset:8192
  v_add_f32 v10, v10, v174
  v_add_f32 v11, v11, v175
  v_cvt_pk_bf16_f32 v199, v174, v175
  v_add_f32 v10, v10, v176
  s_waitcnt lgkmcnt(3)
  v_mfma_f32_32x32x16_bf16 v[144:159], v[46:49], v[232:235], v[144:159]
  ds_read_b128 v[38:41], v23 offset:8192
  v_add_f32 v11, v11, v177
  v_cvt_pk_bf16_f32 v200, v176, v177
  v_add_f32 v10, v10, v178
  v_add_f32 v11, v11, v179
  v_mfma_f32_32x32x16_bf16 v[144:159], v[50:53], v[236:239], v[144:159]
  v_cvt_pk_bf16_f32 v201, v178, v179
  v_add_f32 v10, v10, v180
  v_add_f32 v11, v11, v181
  v_cvt_pk_bf16_f32 v202, v180, v181
  s_waitcnt lgkmcnt(2)
  v_mfma_f32_32x32x16_bf16 v[144:159], v[54:57], v[240:243], v[144:159]
  v_add_f32 v10, v10, v182
  v_add_f32 v11, v11, v183
  v_cvt_pk_bf16_f32 v203, v182, v183
  v_add_f32 v10, v10, v184
  v_mfma_f32_32x32x16_bf16 v[144:159], v[58:61], v[244:247], v[144:159]
  v_add_f32 v11, v11, v185
  v_cvt_pk_bf16_f32 v204, v184, v185
  v_add_f32 v10, v10, v186
  v_add_f32 v11, v11, v187
  s_waitcnt lgkmcnt(0)
  v_mfma_f32_32x32x16_bf16 v[144:159], v[34:37], v[248:251], v[144:159]
  v_cvt_pk_bf16_f32 v205, v186, v187
  v_add_f32 v10, v10, v188
  v_add_f32 v11, v11, v189
  v_cvt_pk_bf16_f32 v206, v188, v189
  v_mfma_f32_32x32x16_bf16 v[144:159], v[38:41], v[252:255], v[144:159]
  v_add_f32 v10, v10, v190
  v_add_f32 v11, v11, v191
  v_cvt_pk_bf16_f32 v207, v190, v191
  v_add_u32 v24, 0xffff8000, v24
  v_add_u32 v25, 0xffff8000, v25
  v_add_u32 v26, 0xffff8000, v26
  v_add_u32 v27, 0xffff8000, v27
  s_waitcnt vmcnt(8) lgkmcnt(0)
  s_barrier
  s_cmp_eq_u32 s65, 0
  s_cbranch_scc0 K1_SO6
K1_S6:
  ds_read_b64_tr_b16 v[34:35], v24 offset:0
  ds_read_b64_tr_b16 v[36:37], v24 offset:2048
  ds_read_b64_tr_b16 v[38:39], v25 offset:0
  ds_read_b64_tr_b16 v[40:41], v25 offset:2048
  ds_read_b64_tr_b16 v[42:43], v26 offset:0
  ds_read_b64_tr_b16 v[44:45], v26 offset:2048
  ds_read_b64_tr_b16 v[46:47], v27 offset:0
  ds_read_b64_tr_b16 v[48:49], v27 offset:2048
  ds_read_b64_tr_b16 v[50:51], v24 offset:4096
  ds_read_b64_tr_b16 v[52:53], v24 offset:6144
  s_waitcnt lgkmcnt(6)
  v_mfma_f32_32x32x16_bf16 v[64:79], v[34:37], v[192:195], v[64:79]
  ds_read_b64_tr_b16 v[54:55], v25 offset:4096
  ds_read_b64_tr_b16 v[56:57], v25 offset:6144
  s_add_u32 m0, s61, 147456
  s_add_u32 s58, s75, 7
  s_and_b32 s58, s58, 7
  s_lshl_b32 s58, s58, 14
  s_add_u32 s58, s58, s61
  buffer_load_dwordx4 v32, s[40:43], s58 offen offset:0 nt lds
  buffer_load_dwordx4 v32, s[40:43], s58 offen offset:1024 nt lds
  buffer_load_dwordx4 v32, s[40:43], s58 offen offset:2048 nt lds
  buffer_load_dwordx4 v32, s[40:43], s58 offen offset:3072 nt lds
  v_max3_f32 v8, v128, v129, v130
  v_max3_f32 v9, v144, v145, v146
  v_max3_f32 v8, v8, v131, v132
  v_max3_f32 v9, v9, v147, v148
  v_mfma_f32_32x32x16_bf16 v[80:95], v[38:41], v[192:195], v[80:95]
  ds_read_b64_tr_b16 v[58:59], v26 offset:4096
  ds_read_b64_tr_b16 v[60:61], v26 offset:6144
  v_max3_f32 v8, v8, v133, v134
  v_max3_f32 v9, v9, v149, v150
  v_max3_f32 v8, v8, v135, v136
  v_max3_f32 v9, v9, v151, v152
  s_waitcnt lgkmcnt(6)
  v_mfma_f32_32x32x16_bf16 v[96:111], v[42:45], v[192:195], v[96:111]
  ds_read_b64_tr_b16 v[34:35], v27 offset:4096
  ds_read_b64_tr_b16 v[36:37], v27 offset:6144
  v_max3_f32 v8, v8, v137, v138
  v_max3_f32 v9, v9, v153, v154
  v_max3_f32 v8, v8, v139, v140
  v_max3_f32 v9, v9, v155, v156
  v_mfma_f32_32x32x16_bf16 v[112:127], v[46:49], v[192:195], v[112:127]
  ds_read_b64_tr_b16 v[38:39], v24 offset:8192
  ds_read_b64_tr_b16 v[40:41], v24 offset:10240
  v_max3_f32 v8, v8, v141, v142
  v_max3_f32 v9, v9, v157, v158
  v_max3_f32 v8, v8, v143, v159
  v_max_f32 v8, v8, v9
  s_waitcnt lgkmcnt(6)
  v_mfma_f32_32x32x16_bf16 v[64:79], v[50:53], v[196:199], v[64:79]
  ds_read_b64_tr_b16 v[42:43], v25 offset:8192
  ds_read_b64_tr_b16 v[44:45], v25 offset:10240
  v_mov_b32 v9, v8
  s_nop 1
  v_permlane32_swap_b32 v8, v9
  v_max_f32 v8, v8, v9
  v_cmp_lt_f32 vcc, s64, v8
  s_mov_b32 s65, 0
  s_cmp_lg_u64 vcc, 0
  s_cbranch_scc1 K1_RO6
K1_R6:
  v_mfma_f32_32x32x16_bf16 v[80:95], v[54:57], v[196:199], v[80:95]
  ds_read_b64_tr_b16 v[46:47], v26 offset:8192
  ds_read_b64_tr_b16 v[48:49], v26 offset:10240
  v_exp_f32 v128, v128
  v_exp_f32 v129, v129
  s_waitcnt lgkmcnt(6)
  v_mfma_f32_32x32x16_bf16 v[96:111], v[58:61], v[196:199], v[96:111]
  ds_read_b64_tr_b16 v[50:51], v27 offset:8192
  ds_read_b64_tr_b16 v[52:53], v27 offset:10240
  v_exp_f32 v130, v130
  v_exp_f32 v131, v131
  v_mfma_f32_32x32x16_bf16 v[112:127], v[34:37], v[196:199], v[112:127]
  ds_read_b64_tr_b16 v[54:55], v24 offset:12288
  ds_read_b64_tr_b16 v[56:57], v24 offset:14336
  v_exp_f32 v132, v132
  s_waitcnt lgkmcnt(6)
  v_mfma_f32_32x32x16_bf16 v[64:79], v[38:41], v[200:203], v[64:79]
  ds_read_b64_tr_b16 v[58:59], v25 offset:12288
  ds_read_b64_tr_b16 v[60:61], v25 offset:14336
  v_exp_f32 v133, v133
  v_exp_f32 v134, v134
  v_mfma_f32_32x32x16_bf16 v[80:95], v[42:45], v[200:203], v[80:95]
  ds_read_b64_tr_b16 v[34:35], v26 offset:12288
  ds_read_b64_tr_b16 v[36:37], v26 offset:14336
  v_exp_f32 v135, v135
  v_exp_f32 v136, v136
  s_waitcnt lgkmcnt(6)
  v_mfma_f32_32x32x16_bf16 v[96:111], v[46:49], v[200:203], v[96:111]
  ds_read_b64_tr_b16 v[38:39], v27 offset:12288
  ds_read_b64_tr_b16 v[40:41], v27 offset:14336
  v_exp_f32 v137, v137
  v_mfma_f32_32x32x16_bf16 v[112:127], v[50:53], v[200:203], v[112:127]
  v_exp_f32 v138, v138
  v_exp_f32 v139, v139
  s_waitcnt lgkmcnt(4)
  v_mfma_f32_32x32x16_bf16 v[64:79], v[54:57], v[204:207], v[64:79]
  v_exp_f32 v140, v140
  v_exp_f32 v141, v141
  v_mfma_f32_32x32x16_bf16 v[80:95], v[58:61], v[204:207], v[80:95]
  v_exp_f32 v142, v142
  s_waitcnt lgkmcnt(0)
  v_mfma_f32_32x32x16_bf16 v[96:111], v[34:37], v[204:207], v[96:111]
  v_exp_f32 v143, v143
  v_exp_f32 v144, v144
  v_mfma_f32_32x32x16_bf16 v[112:127], v[38:41], v[204:207], v[112:127]
  v_exp_f32 v145, v145
  v_add_u32 v16, 0xffff8000, v16
  v_add_u32 v17, 0xffff8000, v17
  v_add_u32 v18, 0xffff8000, v18
  v_add_u32 v19, 0xffff8000, v19
  v_add_u32 v20, 0xffff8000, v20
  v_add_u32 v21, 0xffff8000, v21
  v_add_u32 v22, 0xffff8000, v22
  v_add_u32 v23, 0xffff8000, v23
  s_waitcnt vmcnt(8) lgkmcnt(0)
  s_barrier
  ds_read_b128 v[34:37], v16 offset:0
  ds_read_b128 v[38:41], v17 offset:0
  ds_read_b128 v[42:45], v18 offset:0
  ds_read_b128 v[46:49], v19 offset:0
  ds_read_b128 v[50:53], v20 offset:0
  s_waitcnt lgkmcnt(3)
  v_mfma_f32_32x32x16_bf16 v[160:175], v[34:37], v[224:227], v[208:223]
  ds_read_b128 v[54:57], v21 offset:0
  v_exp_f32 v146, v146
  v_exp_f32 v147, v147
  v_exp_f32 v148, v148
  v_exp_f32 v149, v149
  v_mfma_f32_32x32x16_bf16 v[160:175], v[38:41], v[228:231], v[160:175]
  ds_read_b128 v[58:61], v22 offset:0
  v_exp_f32 v150, v150
  v_exp_f32 v151, v151
  v_exp_f32 v152, v152
  v_exp_f32 v153, v153
  s_waitcnt lgkmcnt(3)
  v_mfma_f32_32x32x16_bf16 v[160:175], v[42:45], v[232:235], v[160:175]
  ds_read_b128 v[34:37], v23 offset:0
  v_exp_f32 v154, v154
  v_exp_f32 v155, v155
  v_exp_f32 v156, v156
  v_exp_f32 v157, v157
  v_mfma_f32_32x32x16_bf16 v[160:175], v[46:49], v[236:239], v[160:175]
  ds_read_b128 v[38:41], v16 offset:8192
  v_exp_f32 v158, v158
  v_exp_f32 v159, v159
  v_add_f32 v10, v10, v128
  v_add_f32 v11, v11, v129
  s_waitcnt lgkmcnt(3)
  v_mfma_f32_32x32x16_bf16 v[160:175], v[50:53], v[240:243], v[160:175]
  ds_read_b128 v[42:45], v17 offset:8192
  v_cvt_pk_bf16_f32 v192, v128, v129
  v_add_f32 v10, v10, v130
  v_add_f32 v11, v11, v131
  v_cvt_pk_bf16_f32 v193, v130, v131
  v_mfma_f32_32x32x16_bf16 v[160:175], v[54:57], v[244:247], v[160:175]
  ds_read_b128 v[46:49], v18 offset:8192
  v_add_f32 v10, v10, v132
  v_add_f32 v11, v11, v133
  v_cvt_pk_bf16_f32 v194, v132, v133
  v_add_f32 v10, v10, v134
  s_waitcnt lgkmcnt(3)
  v_mfma_f32_32x32x16_bf16 v[160:175], v[58:61], v[248:251], v[160:175]
  ds_read_b128 v[50:53], v19 offset:8192
  v_add_f32 v11, v11, v135
  v_cvt_pk_bf16_f32 v195, v134, v135
  v_add_f32 v10, v10, v136
  v_add_f32 v11, v11, v137
  v_mfma_f32_32x32x16_bf16 v[160:175], v[34:37], v[252:255], v[160:175]
  ds_read_b128 v[54:57], v20 offset:8192
  v_cvt_pk_bf16_f32 v196, v136, v137
  v_add_f32 v10, v10, v138
  v_add_f32 v11, v11, v139
  s_waitcnt lgkmcnt(3)
  v_mfma_f32_32x32x16_bf16 v[176:191], v[38:41], v[224:227], v[208:223]
  ds_read_b128 v[58:61], v21 offset:8192
  v_cvt_pk_bf16_f32 v197, v138, v139
  v_add_f32 v10, v10, v140
  v_add_f32 v11, v11, v141
  v_cvt_pk_bf16_f32 v198, v140, v141
  v_mfma_f32_32x32x16_bf16 v[176:191], v[42:45], v[228:231], v[176:191]
  ds_read_b128 v[34:37], v22 offset:8192
  v_add_f32 v10, v10, v142
  v_add_f32 v11, v11, v143
  v_cvt_pk_bf16_f32 v199, v142, v143
  v_add_f32 v10, v10, v144
  s_waitcnt lgkmcnt(3)
  v_mfma_f32_32x32x16_bf16 v[176:191], v[46:49], v[232:235], v[176:191]
  ds_read_b128 v[38:41], v23 offset:8192
  v_add_f32 v11, v11, v145
  v_cvt_pk_bf16_f32 v200, v144, v145
  v_add_f32 v10, v10, v146
  v_add_f32 v11, v11, v147
  v_mfma_f32_32x32x16_bf16 v[176:191], v[50:53], v[236:239], v[176:191]
  v_cvt_pk_bf16_f32 v201, v146, v147
  v_add_f32 v10, v10, v148
  v_add_f32 v11, v11, v149
  v_cvt_pk_bf16_f32 v202, v148, v149
  s_waitcnt lgkmcnt(2)
  v_mfma_f32_32x32x16_bf16 v[176:191], v[54:57], v[240:243], v[176:191]
  v_add_f32 v10, v10, v150
  v_add_f32 v11, v11, v151
  v_cvt_pk_bf16_f32 v203, v150, v151
  v_add_f32 v10, v10, v152
  v_mfma_f32_32x32x16_bf16 v[176:191], v[58:61], v[244:247], v[176:191]
  v_add_f32 v11, v11, v153
  v_cvt_pk_bf16_f32 v204, v152, v153
  v_add_f32 v10, v10, v154
  v_add_f32 v11, v11, v155
  s_waitcnt lgkmcnt(0)
  v_mfma_f32_32x32x16_bf16 v[176:191], v[34:37], v[248:251], v[176:191]
  v_cvt_pk_bf16_f32 v205, v154, v155
  v_add_f32 v10, v10, v156
  v_add_f32 v11, v11, v157
  v_cvt_pk_bf16_f32 v206, v156, v157
  v_mfma_f32_32x32x16_bf16 v[176:191], v[38:41], v[252:255], v[176:191]
  v_add_f32 v10, v10, v158
  v_add_f32 v11, v11, v159
  v_cvt_pk_bf16_f32 v207, v158, v159
  v_add_u32 v24, 0x8000, v24
  v_add_u32 v25, 0x8000, v25
  v_add_u32 v26, 0x8000, v26
  v_add_u32 v27, 0x8000, v27
  s_waitcnt vmcnt(4) lgkmcnt(0)
  s_barrier
  s_cmp_eq_u32 s65, 0
  s_cbranch_scc0 K1_SO7
K1_S7:
  ds_read_b64_tr_b16 v[34:35], v24 offset:0
  ds_read_b64_tr_b16 v[36:37], v24 offset:2048
  ds_read_b64_tr_b16 v[38:39], v25 offset:0
  ds_read_b64_tr_b16 v[40:41], v25 offset:2048
  ds_read_b64_tr_b16 v[42:43], v26 offset:0
  ds_read_b64_tr_b16 v[44:45], v26 offset:2048
  ds_read_b64_tr_b16 v[46:47], v27 offset:0
  ds_read_b64_tr_b16 v[48:49], v27 offset:2048
  ds_read_b64_tr_b16 v[50:51], v24 offset:4096
  ds_read_b64_tr_b16 v[52:53], v24 offset:6144
  s_waitcnt lgkmcnt(6)
  v_mfma_f32_32x32x16_bf16 v[64:79], v[34:37], v[192:195], v[64:79]
  ds_read_b64_tr_b16 v[54:55], v25 offset:4096
  ds_read_b64_tr_b16 v[56:57], v25 offset:6144
  v_max3_f32 v8, v160, v161, v162
  v_max3_f32 v9, v176, v177, v178
  v_max3_f32 v8, v8, v163, v164
  v_max3_f32 v9, v9, v179, v180
  v_mfma_f32_32x32x16_bf16 v[80:95], v[38:41], v[192:195], v[80:95]
  ds_read_b64_tr_b16 v[58:59], v26 offset:4096
  ds_read_b64_tr_b16 v[60:61], v26 offset:6144
  v_max3_f32 v8, v8, v165, v166
  v_max3_f32 v9, v9, v181, v182
  v_max3_f32 v8, v8, v167, v168
  v_max3_f32 v9, v9, v183, v184
  s_waitcnt lgkmcnt(6)
  v_mfma_f32_32x32x16_bf16 v[96:111], v[42:45], v[192:195], v[96:111]
  ds_read_b64_tr_b16 v[34:35], v27 offset:4096
  ds_read_b64_tr_b16 v[36:37], v27 offset:6144
  v_max3_f32 v8, v8, v169, v170
  v_max3_f32 v9, v9, v185, v186
  v_max3_f32 v8, v8, v171, v172
  v_max3_f32 v9, v9, v187, v188
  v_mfma_f32_32x32x16_bf16 v[112:127], v[46:49], v[192:195], v[112:127]
  ds_read_b64_tr_b16 v[38:39], v24 offset:8192
  ds_read_b64_tr_b16 v[40:41], v24 offset:10240
  v_max3_f32 v8, v8, v173, v174
  v_max3_f32 v9, v9, v189, v190
  v_max3_f32 v8, v8, v175, v191
  v_max_f32 v8, v8, v9
  s_waitcnt lgkmcnt(6)
  v_mfma_f32_32x32x16_bf16 v[64:79], v[50:53], v[196:199], v[64:79]
  ds_read_b64_tr_b16 v[42:43], v25 offset:8192
  ds_read_b64_tr_b16 v[44:45], v25 offset:10240
  v_mov_b32 v9, v8
  s_nop 1
  v_permlane32_swap_b32 v8, v9
  v_max_f32 v8, v8, v9
  v_cmp_lt_f32 vcc, s64, v8
  s_mov_b32 s65, 0
  s_cmp_lg_u64 vcc, 0
  s_cbranch_scc1 K1_RO7
K1_R7:
  v_mfma_f32_32x32x16_bf16 v[80:95], v[54:57], v[196:199], v[80:95]
  ds_read_b64_tr_b16 v[46:47], v26 offset:8192
  ds_read_b64_tr_b16 v[48:49], v26 offset:10240
  v_exp_f32 v160, v160
  v_exp_f32 v161, v161
  s_waitcnt lgkmcnt(6)
  v_mfma_f32_32x32x16_bf16 v[96:111], v[58:61], v[196:199], v[96:111]
  ds_read_b64_tr_b16 v[50:51], v27 offset:8192
  ds_read_b64_tr_b16 v[52:53], v27 offset:10240
  v_exp_f32 v162, v162
  v_exp_f32 v163, v163
  v_mfma_f32_32x32x16_bf16 v[112:127], v[34:37], v[196:199], v[112:127]
  ds_read_b64_tr_b16 v[54:55], v24 offset:12288
  ds_read_b64_tr_b16 v[56:57], v24 offset:14336
  v_exp_f32 v164, v164
  s_waitcnt lgkmcnt(6)
  v_mfma_f32_32x32x16_bf16 v[64:79], v[38:41], v[200:203], v[64:79]
  ds_read_b64_tr_b16 v[58:59], v25 offset:12288
  ds_read_b64_tr_b16 v[60:61], v25 offset:14336
  v_exp_f32 v165, v165
  v_exp_f32 v166, v166
  v_mfma_f32_32x32x16_bf16 v[80:95], v[42:45], v[200:203], v[80:95]
  ds_read_b64_tr_b16 v[34:35], v26 offset:12288
  ds_read_b64_tr_b16 v[36:37], v26 offset:14336
  v_exp_f32 v167, v167
  v_exp_f32 v168, v168
  s_waitcnt lgkmcnt(6)
  v_mfma_f32_32x32x16_bf16 v[96:111], v[46:49], v[200:203], v[96:111]
  ds_read_b64_tr_b16 v[38:39], v27 offset:12288
  ds_read_b64_tr_b16 v[40:41], v27 offset:14336
  v_exp_f32 v169, v169
  v_mfma_f32_32x32x16_bf16 v[112:127], v[50:53], v[200:203], v[112:127]
  v_exp_f32 v170, v170
  v_exp_f32 v171, v171
  s_waitcnt lgkmcnt(4)
  v_mfma_f32_32x32x16_bf16 v[64:79], v[54:57], v[204:207], v[64:79]
  v_exp_f32 v172, v172
  v_exp_f32 v173, v173
  v_mfma_f32_32x32x16_bf16 v[80:95], v[58:61], v[204:207], v[80:95]
  v_exp_f32 v174, v174
  s_waitcnt lgkmcnt(0)
  v_mfma_f32_32x32x16_bf16 v[96:111], v[34:37], v[204:207], v[96:111]
  v_exp_f32 v175, v175
  v_exp_f32 v176, v176
  v_mfma_f32_32x32x16_bf16 v[112:127], v[38:41], v[204:207], v[112:127]
  v_exp_f32 v177, v177
  v_exp_f32 v178, v178
  v_exp_f32 v179, v179
  v_exp_f32 v180, v180
  v_exp_f32 v181, v181
  v_exp_f32 v182, v182
  v_exp_f32 v183, v183
  v_exp_f32 v184, v184
  v_exp_f32 v185, v185
  v_exp_f32 v186, v186
  v_exp_f32 v187, v187
  v_exp_f32 v188, v188
  v_exp_f32 v189, v189
  v_exp_f32 v190, v190
  v_exp_f32 v191, v191
  v_add_f32 v10, v10, v160
  v_add_f32 v11, v11, v161
  v_cvt_pk_bf16_f32 v192, v160, v161
  v_add_f32 v10, v10, v162
  v_add_f32 v11, v11, v163
  v_cvt_pk_bf16_f32 v193, v162, v163
  v_add_f32 v10, v10, v164
  v_add_f32 v11, v11, v165
  v_cvt_pk_bf16_f32 v194, v164, v165
  v_add_f32 v10, v10, v166
  v_add_f32 v11, v11, v167
  v_cvt_pk_bf16_f32 v195, v166, v167
  v_add_f32 v10, v10, v168
  v_add_f32 v11, v11, v169
  v_cvt_pk_bf16_f32 v196, v168, v169
  v_add_f32 v10, v10, v170
  v_add_f32 v11, v11, v171
  v_cvt_pk_bf16_f32 v197, v170, v171
  v_add_f32 v10, v10, v172
  v_add_f32 v11, v11, v173
  v_cvt_pk_bf16_f32 v198, v172, v173
  v_add_f32 v10, v10, v174
  v_add_f32 v11, v11, v175
  v_cvt_pk_bf16_f32 v199, v174, v175
  v_add_f32 v10, v10, v176
  v_add_f32 v11, v11, v177
  v_cvt_pk_bf16_f32 v200, v176, v177
  v_add_f32 v10, v10, v178
  v_add_f32 v11, v11, v179
  v_cvt_pk_bf16_f32 v201, v178, v179
  v_add_f32 v10, v10, v180
  v_add_f32 v11, v11, v181
  v_cvt_pk_bf16_f32 v202, v180, v181
  v_add_f32 v10, v10, v182
  v_add_f32 v11, v11, v183
  v_cvt_pk_bf16_f32 v203, v182, v183
  v_add_f32 v10, v10, v184
  v_add_f32 v11, v11, v185
  v_cvt_pk_bf16_f32 v204, v184, v185
  v_add_f32 v10, v10, v186
  v_add_f32 v11, v11, v187
  v_cvt_pk_bf16_f32 v205, v186, v187
  v_add_f32 v10, v10, v188
  v_add_f32 v11, v11, v189
  v_cvt_pk_bf16_f32 v206, v188, v189
  v_add_f32 v10, v10, v190
  v_add_f32 v11, v11, v191
  v_cvt_pk_bf16_f32 v207, v190, v191
  v_add_f32 v10, v10, v11
  v_mov_b32 v8, v10
  s_nop 1
  v_permlane32_swap_b32 v10, v8
  v_add_f32 v10, v10, v8
  v_rcp_f32 v10, v10
  s_lshl_b32 s54, s20, 13
  v_add_u32 v1, s54, v33
  s_cmp_eq_u32 s65, 0
  s_cbranch_scc0 K1_SO8
K1_S8:
  v_add_u32 v24, 0x4000, v24
  v_add_u32 v25, 0x4000, v25
  v_add_u32 v26, 0x4000, v26
  v_add_u32 v27, 0x4000, v27
  s_waitcnt vmcnt(0) lgkmcnt(0)
  s_barrier
  ds_read_b64_tr_b16 v[34:35], v24 offset:0
  ds_read_b64_tr_b16 v[36:37], v24 offset:2048
  ds_read_b64_tr_b16 v[38:39], v24 offset:4096
  ds_read_b64_tr_b16 v[40:41], v24 offset:6144
  ds_read_b64_tr_b16 v[42:43], v24 offset:8192
  ds_read_b64_tr_b16 v[44:45], v24 offset:10240
  ds_read_b64_tr_b16 v[46:47], v24 offset:12288
  ds_read_b64_tr_b16 v[48:49], v24 offset:14336
  ds_read_b64_tr_b16 v[50:51], v25 offset:0
  ds_read_b64_tr_b16 v[52:53], v25 offset:2048
  s_waitcnt lgkmcnt(6)
  v_mfma_f32_32x32x16_bf16 v[64:79], v[34:37], v[192:195], v[64:79]
  ds_read_b64_tr_b16 v[54:55], v25 offset:4096
  ds_read_b64_tr_b16 v[56:57], v25 offset:6144
  v_mfma_f32_32x32x16_bf16 v[64:79], v[38:41], v[196:199], v[64:79]
  ds_read_b64_tr_b16 v[58:59], v25 offset:8192
  ds_read_b64_tr_b16 v[60:61], v25 offset:10240
  s_waitcnt lgkmcnt(6)
  v_mfma_f32_32x32x16_bf16 v[64:79], v[42:45], v[200:203], v[64:79]
  ds_read_b64_tr_b16 v[34:35], v25 offset:12288
  ds_read_b64_tr_b16 v[36:37], v25 offset:14336
  v_mfma_f32_32x32x16_bf16 v[64:79], v[46:49], v[204:207], v[64:79]
  ds_read_b64_tr_b16 v[38:39], v26 offset:0
  ds_read_b64_tr_b16 v[40:41], v26 offset:2048
  s_waitcnt lgkmcnt(6)
  v_mfma_f32_32x32x16_bf16 v[80:95], v[50:53], v[192:195], v[80:95]
  ds_read_b64_tr_b16 v[42:43], v26 offset:4096
  ds_read_b64_tr_b16 v[44:45], v26 offset:6144
  v_mfma_f32_32x32x16_bf16 v[80:95], v[54:57], v[196:199], v[80:95]
  ds_read_b64_tr_b16 v[46:47], v26 offset:8192
  ds_read_b64_tr_b16 v[48:49], v26 offset:10240
  s_waitcnt lgkmcnt(6)
  v_mfma_f32_32x32x16_bf16 v[80:95], v[58:61], v[200:203], v[80:95]
  ds_read_b64_tr_b16 v[50:51], v26 offset:12288
  ds_read_b64_tr_b16 v[52:53], v26 offset:14336
  v_mfma_f32_32x32x16_bf16 v[80:95], v[34:37], v[204:207], v[80:95]
  ds_read_b64_tr_b16 v[54:55], v27 offset:0
  ds_read_b64_tr_b16 v[56:57], v27 offset:2048
  v_mul_f32 v64, v10, v64
  v_mul_f32 v65, v10, v65
  v_mul_f32 v66, v10, v66
  v_mul_f32 v67, v10, v67
  v_mul_f32 v68, v10, v68
  v_mul_f32 v69, v10, v69
  v_mul_f32 v70, v10, v70
  v_mul_f32 v71, v10, v71
  v_cvt_pk_bf16_f32 v128, v64, v65
  s_waitcnt lgkmcnt(6)
  v_mfma_f32_32x32x16_bf16 v[96:111], v[38:41], v[192:195], v[96:111]
  ds_read_b64_tr_b16 v[58:59], v27 offset:4096
  ds_read_b64_tr_b16 v[60:61], v27 offset:6144
  v_cvt_pk_bf16_f32 v129, v66, v67
  v_cvt_pk_bf16_f32 v130, v68, v69
  v_cvt_pk_bf16_f32 v131, v70, v71
  s_mov_b32 s55, 0
  buffer_store_dwordx4 v[128:131], v1, s[44:47], s55 offen offset:0 sc1
  v_mul_f32 v72, v10, v72
  v_mul_f32 v73, v10, v73
  v_mul_f32 v74, v10, v74
  v_mul_f32 v75, v10, v75
  v_mfma_f32_32x32x16_bf16 v[96:111], v[42:45], v[196:199], v[96:111]
  ds_read_b64_tr_b16 v[34:35], v27 offset:8192
  ds_read_b64_tr_b16 v[36:37], v27 offset:10240
  v_mul_f32 v76, v10, v76
  v_mul_f32 v77, v10, v77
  v_mul_f32 v78, v10, v78
  v_mul_f32 v79, v10, v79
  v_cvt_pk_bf16_f32 v132, v72, v73
  v_cvt_pk_bf16_f32 v133, v74, v75
  v_cvt_pk_bf16_f32 v134, v76, v77
  v_cvt_pk_bf16_f32 v135, v78, v79
  s_mov_b32 s55, 0
  buffer_store_dwordx4 v[132:135], v1, s[44:47], s55 offen offset:1024 sc1
  s_waitcnt lgkmcnt(6)
  v_mfma_f32_32x32x16_bf16 v[96:111], v[46:49], v[200:203], v[96:111]
  ds_read_b64_tr_b16 v[38:39], v27 offset:12288
  ds_read_b64_tr_b16 v[40:41], v27 offset:14336
  v_mfma_f32_32x32x16_bf16 v[96:111], v[50:53], v[204:207], v[96:111]
  v_mul_f32 v80, v10, v80
  v_mul_f32 v81, v10, v81
  v_mul_f32 v82, v10, v82
  v_mul_f32 v83, v10, v83
  v_mul_f32 v84, v10, v84
  v_mul_f32 v85, v10, v85
  v_mul_f32 v86, v10, v86
  v_mul_f32 v87, v10, v87
  v_cvt_pk_bf16_f32 v136, v80, v81
  s_waitcnt lgkmcnt(4)
  v_mfma_f32_32x32x16_bf16 v[112:127], v[54:57], v[192:195], v[112:127]
  v_cvt_pk_bf16_f32 v137, v82, v83
  v_cvt_pk_bf16_f32 v138, v84, v85
  v_cvt_pk_bf16_f32 v139, v86, v87
  s_mov_b32 s55, 0
  buffer_store_dwordx4 v[136:139], v1, s[44:47], s55 offen offset:2048 sc1
  v_mul_f32 v88, v10, v88
  v_mul_f32 v89, v10, v89
  v_mul_f32 v90, v10, v90
  v_mul_f32 v91, v10, v91
  v_mfma_f32_32x32x16_bf16 v[112:127], v[58:61], v[196:199], v[112:127]
  v_mul_f32 v92, v10, v92
  v_mul_f32 v93, v10, v93
  v_mul_f32 v94, v10, v94
  v_mul_f32 v95, v10, v95
  v_cvt_pk_bf16_f32 v140, v88, v89
  v_cvt_pk_bf16_f32 v141, v90, v91
  v_cvt_pk_bf16_f32 v142, v92, v93
  v_cvt_pk_bf16_f32 v143, v94, v95
  s_mov_b32 s55, 0
  buffer_store_dwordx4 v[140:143], v1, s[44:47], s55 offen offset:3072 sc1
  s_waitcnt lgkmcnt(0)
  v_mfma_f32_32x32x16_bf16 v[112:127], v[34:37], v[200:203], v[112:127]
  v_mfma_f32_32x32x16_bf16 v[112:127], v[38:41], v[204:207], v[112:127]
  v_mul_f32 v96, v10, v96
  v_mul_f32 v97, v10, v97
  v_mul_f32 v98, v10, v98
  v_mul_f32 v99, v10, v99
  v_mul_f32 v100, v10, v100
  v_mul_f32 v101, v10, v101
  v_mul_f32 v102, v10, v102
  v_mul_f32 v103, v10, v103
  v_cvt_pk_bf16_f32 v144, v96, v97
  v_cvt_pk_bf16_f32 v145, v98, v99
  v_cvt_pk_bf16_f32 v146, v100, v101
  v_cvt_pk_bf16_f32 v147, v102, v103
  s_mov_b32 s55, 4096
  buffer_store_dwordx4 v[144:147], v1, s[44:47], s55 offen offset:0 sc1
  v_mul_f32 v104, v10, v104
  v_mul_f32 v105, v10, v105
  v_mul_f32 v106, v10, v106
  v_mul_f32 v107, v10, v107
  v_mul_f32 v108, v10, v108
  v_mul_f32 v109, v10, v109
  v_mul_f32 v110, v10, v110
  v_mul_f32 v111, v10, v111
  v_cvt_pk_bf16_f32 v148, v104, v105
  v_cvt_pk_bf16_f32 v149, v106, v107
  v_cvt_pk_bf16_f32 v150, v108, v109
  v_cvt_pk_bf16_f32 v151, v110, v111
  s_mov_b32 s55, 4096
  buffer_store_dwordx4 v[148:151], v1, s[44:47], s55 offen offset:1024 sc1
  v_mul_f32 v112, v10, v112
  v_mul_f32 v113, v10, v113
  v_mul_f32 v114, v10, v114
  v_mul_f32 v115, v10, v115
  v_mul_f32 v116, v10, v116
  v_mul_f32 v117, v10, v117
  v_mul_f32 v118, v10, v118
  v_mul_f32 v119, v10, v119
  v_cvt_pk_bf16_f32 v152, v112, v113
  v_cvt_pk_bf16_f32 v153, v114, v115
  v_cvt_pk_bf16_f32 v154, v116, v117
  v_cvt_pk_bf16_f32 v155, v118, v119
  s_mov_b32 s55, 4096
  buffer_store_dwordx4 v[152:155], v1, s[44:47], s55 offen offset:2048 sc1
  v_mul_f32 v120, v10, v120
  v_mul_f32 v121, v10, v121
  v_mul_f32 v122, v10, v122
  v_mul_f32 v123, v10, v123
  v_mul_f32 v124, v10, v124
  v_mul_f32 v125, v10, v125
  v_mul_f32 v126, v10, v126
  v_mul_f32 v127, v10, v127
  v_cvt_pk_bf16_f32 v156, v120, v121
  v_cvt_pk_bf16_f32 v157, v122, v123
  v_cvt_pk_bf16_f32 v158, v124, v125
  v_cvt_pk_bf16_f32 v159, v126, v127
  s_mov_b32 s55, 4096
  buffer_store_dwordx4 v[156:159], v1, s[44:47], s55 offen offset:3072 sc1
  s_and_b32 s56, s20, 1
  s_lshr_b32 s57, s20, 1
  s_lshl_b32 s59, s56, 1
  v_lshrrev_b32 v1, 5, v0
  v_bfe_u32 v2, v0, 4, 1
  v_bfe_u32 v3, v0, 2, 2
  v_and_b32 v4, 1, v0
  v_bfe_u32 v5, v0, 1, 1
  v_lshl_add_u32 v4, v2, 1, v4
  v_mul_u32_u24 v6, 8, v1
  v_add_u32 v6, v6, v3
  v_lshlrev_b32 v6, 8, v6
  v_lshl_add_u32 v6, v5, 3, v6
  v_lshl_add_u32 v6, v4, 4, v6
  s_add_u32 s54, s59, 0
  v_xor_b32 v7, s54, v3
  v_lshl_add_u32 v192, v7, 6, v6
  s_add_u32 s54, s59, 1
  v_xor_b32 v7, s54, v3
  v_lshl_add_u32 v193, v7, 6, v6
  v_add_u32 v192, 49152, v192
  v_add_u32 v193, 49152, v193
  s_lshl_b32 s54, s57, 13
  v_add_u32 v194, s54, v33
  s_lshl_b32 s78, s53, 7
  s_lshl_b32 s65, s57, 6
  s_add_u32 s78, s78, s65
  s_and_b32 s65, s27, 1
  s_lshl_b32 s65, s65, 5
  s_add_u32 s78, s78, s65
  s_lshl_b32 s78, s78, 11
  s_lshl_b32 s65, s67, 8
  s_add_u32 s78, s78, s65
  s_lshl_b32 s65, s56, 7
  s_add_u32 s78, s78, s65
  s_lshr_b32 s65, s27, 1
  s_lshl_b32 s65, s65, 6
  s_add_u32 s78, s78, s65
  v_and_b32 v2, 31, v0
  v_lshlrev_b32 v2, 11, v2
  v_lshrrev_b32 v3, 5, v0
  v_lshl_add_u32 v40, v3, 4, v2
  s_lshl_b32 s61, s20, 12
  v_add_u32 v41, s61, v33
  s_lshl_b32 s66, s27, 14
  s_waitcnt vmcnt(0)
  s_barrier
  s_lshl_b32 s54, s26, 18
  s_add_u32 s54, s54, 8388608
  s_add_u32 s44, s18, s54
  s_addc_u32 s45, s19, 0
  s_mov_b32 s46, 0x40000
  s_mov_b32 s47, 0x20000
  s_mov_b32 s36, s14
  s_mov_b32 s37, s15
  s_mov_b32 s38, 0x200000
  s_mov_b32 s39, 0x20000
  s_lshl_b32 s54, s26, 9
  s_add_u32 s54, s54, 33619968
  s_add_u32 s40, s18, s54
  s_addc_u32 s41, s19, 0
  s_mov_b32 s42, 0x200
  s_mov_b32 s43, 0x20000
  s_barrier
  v_mov_b32 v1, 98304
  ds_read_b32 v2, v1
  s_waitcnt lgkmcnt(0)
  v_readfirstlane_b32 s74, v2
  s_barrier
  ds_read_b64_tr_b16 v[128:129], v192 offset:0
  ds_read_b64_tr_b16 v[130:131], v192 offset:1024
  ds_read_b128 v[136:139], v194 offset:0
  ds_read_b128 v[140:143], v194 offset:4096
  ds_read_b64_tr_b16 v[132:133], v193 offset:0
  ds_read_b64_tr_b16 v[134:135], v193 offset:1024
  ds_read_b64_tr_b16 v[144:145], v192 offset:4096
  ds_read_b64_tr_b16 v[146:147], v192 offset:5120
  ds_read_b128 v[152:155], v194 offset:1024
  ds_read_b128 v[156:159], v194 offset:5120
  ds_read_b64_tr_b16 v[148:149], v193 offset:4096
  ds_read_b64_tr_b16 v[150:151], v193 offset:5120
  s_waitcnt lgkmcnt(6)
  v_mfma_f32_32x32x16_bf16 v[64:79], v[128:131], v[136:139], 0
  ds_read_b64_tr_b16 v[160:161], v192 offset:8192
  ds_read_b64_tr_b16 v[162:163], v192 offset:9216
  v_mfma_f32_32x32x16_bf16 v[80:95], v[128:131], v[140:143], 0
  ds_read_b128 v[168:171], v194 offset:2048
  ds_read_b128 v[172:175], v194 offset:6144
  v_mfma_f32_32x32x16_bf16 v[96:111], v[132:135], v[136:139], 0
  ds_read_b64_tr_b16 v[164:165], v193 offset:8192
  ds_read_b64_tr_b16 v[166:167], v193 offset:9216
  v_mfma_f32_32x32x16_bf16 v[112:127], v[132:135], v[140:143], 0
  s_waitcnt lgkmcnt(6)
  v_mfma_f32_32x32x16_bf16 v[64:79], v[144:147], v[152:155], v[64:79]
  ds_read_b64_tr_b16 v[128:129], v192 offset:12288
  ds_read_b64_tr_b16 v[130:131], v192 offset:13312
  v_mfma_f32_32x32x16_bf16 v[80:95], v[144:147], v[156:159], v[80:95]
  ds_read_b128 v[136:139], v194 offset:3072
  ds_read_b128 v[140:143], v194 offset:7168
  v_mfma_f32_32x32x16_bf16 v[96:111], v[148:151], v[152:155], v[96:111]
  ds_read_b64_tr_b16 v[132:133], v193 offset:12288
  ds_read_b64_tr_b16 v[134:135], v193 offset:13312
  v_mfma_f32_32x32x16_bf16 v[112:127], v[148:151], v[156:159], v[112:127]
  s_waitcnt lgkmcnt(0)
  s_barrier
  v_mfma_f32_32x32x16_bf16 v[64:79], v[160:163], v[168:171], v[64:79]
  ds_read_b64_tr_b16 v[144:145], v192 offset:16384
  ds_read_b64_tr_b16 v[146:147], v192 offset:17408
  v_mfma_f32_32x32x16_bf16 v[80:95], v[160:163], v[172:175], v[80:95]
  ds_read_b128 v[152:155], v194 offset:16384
  ds_read_b128 v[156:159], v194 offset:20480
  v_mfma_f32_32x32x16_bf16 v[96:111], v[164:167], v[168:171], v[96:111]
  ds_read_b64_tr_b16 v[148:149], v193 offset:16384
  ds_read_b64_tr_b16 v[150:151], v193 offset:17408
  v_mfma_f32_32x32x16_bf16 v[112:127], v[164:167], v[172:175], v[112:127]
  v_mfma_f32_32x32x16_bf16 v[64:79], v[128:131], v[136:139], v[64:79]
  ds_read_b64_tr_b16 v[160:161], v192 offset:20480
  ds_read_b64_tr_b16 v[162:163], v192 offset:21504
  v_mfma_f32_32x32x16_bf16 v[80:95], v[128:131], v[140:143], v[80:95]
  ds_read_b128 v[168:171], v194 offset:17408
  ds_read_b128 v[172:175], v194 offset:21504
  v_mfma_f32_32x32x16_bf16 v[96:111], v[132:135], v[136:139], v[96:111]
  ds_read_b64_tr_b16 v[164:165], v193 offset:20480
  ds_read_b64_tr_b16 v[166:167], v193 offset:21504
  v_mfma_f32_32x32x16_bf16 v[112:127], v[132:135], v[140:143], v[112:127]
  s_waitcnt lgkmcnt(6)
  v_mfma_f32_32x32x16_bf16 v[64:79], v[144:147], v[152:155], v[64:79]
  ds_read_b64_tr_b16 v[128:129], v192 offset:24576
  ds_read_b64_tr_b16 v[130:131], v192 offset:25600
  v_mfma_f32_32x32x16_bf16 v[80:95], v[144:147], v[156:159], v[80:95]
  ds_read_b128 v[136:139], v194 offset:18432
  ds_read_b128 v[140:143], v194 offset:22528
  v_mfma_f32_32x32x16_bf16 v[96:111], v[148:151], v[152:155], v[96:111]
  ds_read_b64_tr_b16 v[132:133], v193 offset:24576
  ds_read_b64_tr_b16 v[134:135], v193 offset:25600
  v_mfma_f32_32x32x16_bf16 v[112:127], v[148:151], v[156:159], v[112:127]
  s_waitcnt lgkmcnt(6)
  v_mfma_f32_32x32x16_bf16 v[64:79], v[160:163], v[168:171], v[64:79]
  ds_read_b64_tr_b16 v[144:145], v192 offset:28672
  ds_read_b64_tr_b16 v[146:147], v192 offset:29696
  v_mfma_f32_32x32x16_bf16 v[80:95], v[160:163], v[172:175], v[80:95]
  ds_read_b128 v[152:155], v194 offset:19456
  ds_read_b128 v[156:159], v194 offset:23552
  v_mfma_f32_32x32x16_bf16 v[96:111], v[164:167], v[168:171], v[96:111]
  ds_read_b64_tr_b16 v[148:149], v193 offset:28672
  ds_read_b64_tr_b16 v[150:151], v193 offset:29696
  v_mfma_f32_32x32x16_bf16 v[112:127], v[164:167], v[172:175], v[112:127]
  s_waitcnt lgkmcnt(0)
  s_barrier
  v_mfma_f32_32x32x16_bf16 v[64:79], v[128:131], v[136:139], v[64:79]
  ds_read_b64_tr_b16 v[160:161], v192 offset:32768
  ds_read_b64_tr_b16 v[162:163], v192 offset:33792
  v_mfma_f32_32x32x16_bf16 v[80:95], v[128:131], v[140:143], v[80:95]
  ds_read_b128 v[168:171], v194 offset:32768
  ds_read_b128 v[172:175], v194 offset:36864
  v_mfma_f32_32x32x16_bf16 v[96:111], v[132:135], v[136:139], v[96:111]
  ds_read_b64_tr_b16 v[164:165], v193 offset:32768
  ds_read_b64_tr_b16 v[166:167], v193 offset:33792
  v_mfma_f32_32x32x16_bf16 v[112:127], v[132:135], v[140:143], v[112:127]
  v_mfma_f32_32x32x16_bf16 v[64:79], v[144:147], v[152:155], v[64:79]
  ds_read_b64_tr_b16 v[128:129], v192 offset:36864
  ds_read_b64_tr_b16 v[130:131], v192 offset:37888
  v_mfma_f32_32x32x16_bf16 v[80:95], v[144:147], v[156:159], v[80:95]
  ds_read_b128 v[136:139], v194 offset:33792
  ds_read_b128 v[140:143], v194 offset:37888
  v_mfma_f32_32x32x16_bf16 v[96:111], v[148:151], v[152:155], v[96:111]
  ds_read_b64_tr_b16 v[132:133], v193 offset:36864
  ds_read_b64_tr_b16 v[134:135], v193 offset:37888
  v_mfma_f32_32x32x16_bf16 v[112:127], v[148:151], v[156:159], v[112:127]
  s_waitcnt lgkmcnt(6)
  v_mfma_f32_32x32x16_bf16 v[64:79], v[160:163], v[168:171], v[64:79]
  ds_read_b64_tr_b16 v[144:145], v192 offset:40960
  ds_read_b64_tr_b16 v[146:147], v192 offset:41984
  v_mfma_f32_32x32x16_bf16 v[80:95], v[160:163], v[172:175], v[80:95]
  ds_read_b128 v[152:155], v194 offset:34816
  ds_read_b128 v[156:159], v194 offset:38912
  v_mfma_f32_32x32x16_bf16 v[96:111], v[164:167], v[168:171], v[96:111]
  ds_read_b64_tr_b16 v[148:149], v193 offset:40960
  ds_read_b64_tr_b16 v[150:151], v193 offset:41984
  v_mfma_f32_32x32x16_bf16 v[112:127], v[164:167], v[172:175], v[112:127]
  s_waitcnt lgkmcnt(6)
  v_mfma_f32_32x32x16_bf16 v[64:79], v[128:131], v[136:139], v[64:79]
  ds_read_b64_tr_b16 v[160:161], v192 offset:45056
  ds_read_b64_tr_b16 v[162:163], v192 offset:46080
  v_mfma_f32_32x32x16_bf16 v[80:95], v[128:131], v[140:143], v[80:95]
  ds_read_b128 v[168:171], v194 offset:35840
  ds_read_b128 v[172:175], v194 offset:39936
  v_mfma_f32_32x32x16_bf16 v[96:111], v[132:135], v[136:139], v[96:111]
  ds_read_b64_tr_b16 v[164:165], v193 offset:45056
  ds_read_b64_tr_b16 v[166:167], v193 offset:46080
  v_mfma_f32_32x32x16_bf16 v[112:127], v[132:135], v[140:143], v[112:127]
  s_waitcnt lgkmcnt(0)
  s_barrier
  v_mfma_f32_32x32x16_bf16 v[64:79], v[144:147], v[152:155], v[64:79]
  ds_read_b64_tr_b16 v[128:129], v192 offset:0
  ds_read_b64_tr_b16 v[130:131], v192 offset:1024
  v_mfma_f32_32x32x16_bf16 v[80:95], v[144:147], v[156:159], v[80:95]
  ds_read_b128 v[136:139], v194 offset:0
  ds_read_b128 v[140:143], v194 offset:4096
  v_mfma_f32_32x32x16_bf16 v[96:111], v[148:151], v[152:155], v[96:111]
  ds_read_b64_tr_b16 v[132:133], v193 offset:0
  ds_read_b64_tr_b16 v[134:135], v193 offset:1024
  v_mfma_f32_32x32x16_bf16 v[112:127], v[148:151], v[156:159], v[112:127]
  v_mfma_f32_32x32x16_bf16 v[64:79], v[160:163], v[168:171], v[64:79]
  ds_read_b64_tr_b16 v[144:145], v192 offset:4096
  ds_read_b64_tr_b16 v[146:147], v192 offset:5120
  v_mfma_f32_32x32x16_bf16 v[80:95], v[160:163], v[172:175], v[80:95]
  ds_read_b128 v[152:155], v194 offset:1024
  ds_read_b128 v[156:159], v194 offset:5120
  v_mfma_f32_32x32x16_bf16 v[96:111], v[164:167], v[168:171], v[96:111]
  ds_read_b64_tr_b16 v[148:149], v193 offset:4096
  ds_read_b64_tr_b16 v[150:151], v193 offset:5120
  v_mfma_f32_32x32x16_bf16 v[112:127], v[164:167], v[172:175], v[112:127]
  s_waitcnt lgkmcnt(6)
  v_mfma_f32_32x32x16_bf16 v[64:79], v[128:131], v[136:139], v[64:79]
  ds_read_b64_tr_b16 v[160:161], v192 offset:8192
  ds_read_b64_tr_b16 v[162:163], v192 offset:9216
  v_mfma_f32_32x32x16_bf16 v[80:95], v[128:131], v[140:143], v[80:95]
  ds_read_b128 v[168:171], v194 offset:2048
  ds_read_b128 v[172:175], v194 offset:6144
  v_mfma_f32_32x32x16_bf16 v[96:111], v[132:135], v[136:139], v[96:111]
  ds_read_b64_tr_b16 v[164:165], v193 offset:8192
  ds_read_b64_tr_b16 v[166:167], v193 offset:9216
  v_mfma_f32_32x32x16_bf16 v[112:127], v[132:135], v[140:143], v[112:127]
  s_waitcnt lgkmcnt(6)
  v_mfma_f32_32x32x16_bf16 v[64:79], v[144:147], v[152:155], v[64:79]
  ds_read_b64_tr_b16 v[128:129], v192 offset:12288
  ds_read_b64_tr_b16 v[130:131], v192 offset:13312
  v_mfma_f32_32x32x16_bf16 v[80:95], v[144:147], v[156:159], v[80:95]
  ds_read_b128 v[136:139], v194 offset:3072
  ds_read_b128 v[140:143], v194 offset:7168
  v_mfma_f32_32x32x16_bf16 v[96:111], v[148:151], v[152:155], v[96:111]
  ds_read_b64_tr_b16 v[132:133], v193 offset:12288
  ds_read_b64_tr_b16 v[134:135], v193 offset:13312
  v_mfma_f32_32x32x16_bf16 v[112:127], v[148:151], v[156:159], v[112:127]
  s_waitcnt lgkmcnt(0)
  s_barrier
  v_mfma_f32_32x32x16_bf16 v[64:79], v[160:163], v[168:171], v[64:79]
  ds_read_b64_tr_b16 v[144:145], v192 offset:16384
  ds_read_b64_tr_b16 v[146:147], v192 offset:17408
  v_mfma_f32_32x32x16_bf16 v[80:95], v[160:163], v[172:175], v[80:95]
  ds_read_b128 v[152:155], v194 offset:16384
  ds_read_b128 v[156:159], v194 offset:20480
  v_mfma_f32_32x32x16_bf16 v[96:111], v[164:167], v[168:171], v[96:111]
  ds_read_b64_tr_b16 v[148:149], v193 offset:16384
  ds_read_b64_tr_b16 v[150:151], v193 offset:17408
  v_mfma_f32_32x32x16_bf16 v[112:127], v[164:167], v[172:175], v[112:127]
  v_mfma_f32_32x32x16_bf16 v[64:79], v[128:131], v[136:139], v[64:79]
  ds_read_b64_tr_b16 v[160:161], v192 offset:20480
  ds_read_b64_tr_b16 v[162:163], v192 offset:21504
  v_mfma_f32_32x32x16_bf16 v[80:95], v[128:131], v[140:143], v[80:95]
  ds_read_b128 v[168:171], v194 offset:17408
  ds_read_b128 v[172:175], v194 offset:21504
  v_mfma_f32_32x32x16_bf16 v[96:111], v[132:135], v[136:139], v[96:111]
  ds_read_b64_tr_b16 v[164:165], v193 offset:20480
  ds_read_b64_tr_b16 v[166:167], v193 offset:21504
  v_mfma_f32_32x32x16_bf16 v[112:127], v[132:135], v[140:143], v[112:127]
  s_waitcnt lgkmcnt(6)
  v_mfma_f32_32x32x16_bf16 v[64:79], v[144:147], v[152:155], v[64:79]
  ds_read_b64_tr_b16 v[128:129], v192 offset:24576
  ds_read_b64_tr_b16 v[130:131], v192 offset:25600
  v_mfma_f32_32x32x16_bf16 v[80:95], v[144:147], v[156:159], v[80:95]
  ds_read_b128 v[136:139], v194 offset:18432
  ds_read_b128 v[140:143], v194 offset:22528
  v_mfma_f32_32x32x16_bf16 v[96:111], v[148:151], v[152:155], v[96:111]
  ds_read_b64_tr_b16 v[132:133], v193 offset:24576
  ds_read_b64_tr_b16 v[134:135], v193 offset:25600
  v_mfma_f32_32x32x16_bf16 v[112:127], v[148:151], v[156:159], v[112:127]
  s_waitcnt lgkmcnt(6)
  v_mfma_f32_32x32x16_bf16 v[64:79], v[160:163], v[168:171], v[64:79]
  ds_read_b64_tr_b16 v[144:145], v192 offset:28672
  ds_read_b64_tr_b16 v[146:147], v192 offset:29696
  v_mfma_f32_32x32x16_bf16 v[80:95], v[160:163], v[172:175], v[80:95]
  ds_read_b128 v[152:155], v194 offset:19456
  ds_read_b128 v[156:159], v194 offset:23552
  v_mfma_f32_32x32x16_bf16 v[96:111], v[164:167], v[168:171], v[96:111]
  ds_read_b64_tr_b16 v[148:149], v193 offset:28672
  ds_read_b64_tr_b16 v[150:151], v193 offset:29696
  v_mfma_f32_32x32x16_bf16 v[112:127], v[164:167], v[172:175], v[112:127]
  s_waitcnt lgkmcnt(0)
  s_barrier
  v_mfma_f32_32x32x16_bf16 v[64:79], v[128:131], v[136:139], v[64:79]
  ds_read_b64_tr_b16 v[160:161], v192 offset:32768
  ds_read_b64_tr_b16 v[162:163], v192 offset:33792
  v_mfma_f32_32x32x16_bf16 v[80:95], v[128:131], v[140:143], v[80:95]
  ds_read_b128 v[168:171], v194 offset:32768
  ds_read_b128 v[172:175], v194 offset:36864
  v_mfma_f32_32x32x16_bf16 v[96:111], v[132:135], v[136:139], v[96:111]
  ds_read_b64_tr_b16 v[164:165], v193 offset:32768
  ds_read_b64_tr_b16 v[166:167], v193 offset:33792
  v_mfma_f32_32x32x16_bf16 v[112:127], v[132:135], v[140:143], v[112:127]
  v_mfma_f32_32x32x16_bf16 v[64:79], v[144:147], v[152:155], v[64:79]
  ds_read_b64_tr_b16 v[128:129], v192 offset:36864
  ds_read_b64_tr_b16 v[130:131], v192 offset:37888
  v_mfma_f32_32x32x16_bf16 v[80:95], v[144:147], v[156:159], v[80:95]
  ds_read_b128 v[136:139], v194 offset:33792
  ds_read_b128 v[140:143], v194 offset:37888
  v_mfma_f32_32x32x16_bf16 v[96:111], v[148:151], v[152:155], v[96:111]
  ds_read_b64_tr_b16 v[132:133], v193 offset:36864
  ds_read_b64_tr_b16 v[134:135], v193 offset:37888
  v_mfma_f32_32x32x16_bf16 v[112:127], v[148:151], v[156:159], v[112:127]
  s_waitcnt lgkmcnt(6)
  v_mfma_f32_32x32x16_bf16 v[64:79], v[160:163], v[168:171], v[64:79]
  ds_read_b64_tr_b16 v[144:145], v192 offset:40960
  ds_read_b64_tr_b16 v[146:147], v192 offset:41984
  v_mfma_f32_32x32x16_bf16 v[80:95], v[160:163], v[172:175], v[80:95]
  ds_read_b128 v[152:155], v194 offset:34816
  ds_read_b128 v[156:159], v194 offset:38912
  v_mfma_f32_32x32x16_bf16 v[96:111], v[164:167], v[168:171], v[96:111]
  ds_read_b64_tr_b16 v[148:149], v193 offset:40960
  ds_read_b64_tr_b16 v[150:151], v193 offset:41984
  v_mfma_f32_32x32x16_bf16 v[112:127], v[164:167], v[172:175], v[112:127]
  s_waitcnt lgkmcnt(6)
  v_mfma_f32_32x32x16_bf16 v[64:79], v[128:131], v[136:139], v[64:79]
  ds_read_b64_tr_b16 v[160:161], v192 offset:45056
  ds_read_b64_tr_b16 v[162:163], v192 offset:46080
  v_mfma_f32_32x32x16_bf16 v[80:95], v[128:131], v[140:143], v[80:95]
  ds_read_b128 v[168:171], v194 offset:35840
  ds_read_b128 v[172:175], v194 offset:39936
  v_mfma_f32_32x32x16_bf16 v[96:111], v[132:135], v[136:139], v[96:111]
  ds_read_b64_tr_b16 v[164:165], v193 offset:45056
  ds_read_b64_tr_b16 v[166:167], v193 offset:46080
  v_mfma_f32_32x32x16_bf16 v[112:127], v[132:135], v[140:143], v[112:127]
  s_waitcnt lgkmcnt(0)
  s_barrier
  v_mfma_f32_32x32x16_bf16 v[64:79], v[144:147], v[152:155], v[64:79]
  ds_read_b64_tr_b16 v[128:129], v192 offset:0
  ds_read_b64_tr_b16 v[130:131], v192 offset:1024
  v_mfma_f32_32x32x16_bf16 v[80:95], v[144:147], v[156:159], v[80:95]
  ds_read_b128 v[136:139], v194 offset:0
  ds_read_b128 v[140:143], v194 offset:4096
  v_mfma_f32_32x32x16_bf16 v[96:111], v[148:151], v[152:155], v[96:111]
  ds_read_b64_tr_b16 v[132:133], v193 offset:0
  ds_read_b64_tr_b16 v[134:135], v193 offset:1024
  v_mfma_f32_32x32x16_bf16 v[112:127], v[148:151], v[156:159], v[112:127]
  v_mfma_f32_32x32x16_bf16 v[64:79], v[160:163], v[168:171], v[64:79]
  ds_read_b64_tr_b16 v[144:145], v192 offset:4096
  ds_read_b64_tr_b16 v[146:147], v192 offset:5120
  v_mfma_f32_32x32x16_bf16 v[80:95], v[160:163], v[172:175], v[80:95]
  ds_read_b128 v[152:155], v194 offset:1024
  ds_read_b128 v[156:159], v194 offset:5120
  v_mfma_f32_32x32x16_bf16 v[96:111], v[164:167], v[168:171], v[96:111]
  ds_read_b64_tr_b16 v[148:149], v193 offset:4096
  ds_read_b64_tr_b16 v[150:151], v193 offset:5120
  v_mfma_f32_32x32x16_bf16 v[112:127], v[164:167], v[172:175], v[112:127]
  s_waitcnt lgkmcnt(6)
  v_mfma_f32_32x32x16_bf16 v[64:79], v[128:131], v[136:139], v[64:79]
  ds_read_b64_tr_b16 v[160:161], v192 offset:8192
  ds_read_b64_tr_b16 v[162:163], v192 offset:9216
  v_mfma_f32_32x32x16_bf16 v[80:95], v[128:131], v[140:143], v[80:95]
  ds_read_b128 v[168:171], v194 offset:2048
  ds_read_b128 v[172:175], v194 offset:6144
  v_mfma_f32_32x32x16_bf16 v[96:111], v[132:135], v[136:139], v[96:111]
  ds_read_b64_tr_b16 v[164:165], v193 offset:8192
  ds_read_b64_tr_b16 v[166:167], v193 offset:9216
  v_mfma_f32_32x32x16_bf16 v[112:127], v[132:135], v[140:143], v[112:127]
  s_waitcnt lgkmcnt(6)
  v_mfma_f32_32x32x16_bf16 v[64:79], v[144:147], v[152:155], v[64:79]
  ds_read_b64_tr_b16 v[128:129], v192 offset:12288
  ds_read_b64_tr_b16 v[130:131], v192 offset:13312
  v_mfma_f32_32x32x16_bf16 v[80:95], v[144:147], v[156:159], v[80:95]
  ds_read_b128 v[136:139], v194 offset:3072
  ds_read_b128 v[140:143], v194 offset:7168
  v_mfma_f32_32x32x16_bf16 v[96:111], v[148:151], v[152:155], v[96:111]
  ds_read_b64_tr_b16 v[132:133], v193 offset:12288
  ds_read_b64_tr_b16 v[134:135], v193 offset:13312
  v_mfma_f32_32x32x16_bf16 v[112:127], v[148:151], v[156:159], v[112:127]
  s_waitcnt lgkmcnt(0)
  s_barrier
  v_mfma_f32_32x32x16_bf16 v[64:79], v[160:163], v[168:171], v[64:79]
  ds_read_b64_tr_b16 v[144:145], v192 offset:16384
  ds_read_b64_tr_b16 v[146:147], v192 offset:17408
  v_mfma_f32_32x32x16_bf16 v[80:95], v[160:163], v[172:175], v[80:95]
  ds_read_b128 v[152:155], v194 offset:16384
  ds_read_b128 v[156:159], v194 offset:20480
  v_mfma_f32_32x32x16_bf16 v[96:111], v[164:167], v[168:171], v[96:111]
  ds_read_b64_tr_b16 v[148:149], v193 offset:16384
  ds_read_b64_tr_b16 v[150:151], v193 offset:17408
  v_mfma_f32_32x32x16_bf16 v[112:127], v[164:167], v[172:175], v[112:127]
  v_mfma_f32_32x32x16_bf16 v[64:79], v[128:131], v[136:139], v[64:79]
  ds_read_b64_tr_b16 v[160:161], v192 offset:20480
  ds_read_b64_tr_b16 v[162:163], v192 offset:21504
  v_mfma_f32_32x32x16_bf16 v[80:95], v[128:131], v[140:143], v[80:95]
  ds_read_b128 v[168:171], v194 offset:17408
  ds_read_b128 v[172:175], v194 offset:21504
  v_mfma_f32_32x32x16_bf16 v[96:111], v[132:135], v[136:139], v[96:111]
  ds_read_b64_tr_b16 v[164:165], v193 offset:20480
  ds_read_b64_tr_b16 v[166:167], v193 offset:21504
  v_mfma_f32_32x32x16_bf16 v[112:127], v[132:135], v[140:143], v[112:127]
  s_waitcnt lgkmcnt(6)
  v_mfma_f32_32x32x16_bf16 v[64:79], v[144:147], v[152:155], v[64:79]
  ds_read_b64_tr_b16 v[128:129], v192 offset:24576
  ds_read_b64_tr_b16 v[130:131], v192 offset:25600
  v_mfma_f32_32x32x16_bf16 v[80:95], v[144:147], v[156:159], v[80:95]
  ds_read_b128 v[136:139], v194 offset:18432
  ds_read_b128 v[140:143], v194 offset:22528
  v_mfma_f32_32x32x16_bf16 v[96:111], v[148:151], v[152:155], v[96:111]
  ds_read_b64_tr_b16 v[132:133], v193 offset:24576
  ds_read_b64_tr_b16 v[134:135], v193 offset:25600
  v_mfma_f32_32x32x16_bf16 v[112:127], v[148:151], v[156:159], v[112:127]
  s_waitcnt lgkmcnt(6)
  v_mfma_f32_32x32x16_bf16 v[64:79], v[160:163], v[168:171], v[64:79]
  ds_read_b64_tr_b16 v[144:145], v192 offset:28672
  ds_read_b64_tr_b16 v[146:147], v192 offset:29696
  v_mfma_f32_32x32x16_bf16 v[80:95], v[160:163], v[172:175], v[80:95]
  ds_read_b128 v[152:155], v194 offset:19456
  ds_read_b128 v[156:159], v194 offset:23552
  v_mfma_f32_32x32x16_bf16 v[96:111], v[164:167], v[168:171], v[96:111]
  ds_read_b64_tr_b16 v[148:149], v193 offset:28672
  ds_read_b64_tr_b16 v[150:151], v193 offset:29696
  v_mfma_f32_32x32x16_bf16 v[112:127], v[164:167], v[172:175], v[112:127]
  s_waitcnt lgkmcnt(0)
  s_barrier
  v_mfma_f32_32x32x16_bf16 v[64:79], v[128:131], v[136:139], v[64:79]
  ds_read_b64_tr_b16 v[160:161], v192 offset:32768
  ds_read_b64_tr_b16 v[162:163], v192 offset:33792
  v_mfma_f32_32x32x16_bf16 v[80:95], v[128:131], v[140:143], v[80:95]
  ds_read_b128 v[168:171], v194 offset:32768
  ds_read_b128 v[172:175], v194 offset:36864
  v_mfma_f32_32x32x16_bf16 v[96:111], v[132:135], v[136:139], v[96:111]
  ds_read_b64_tr_b16 v[164:165], v193 offset:32768
  ds_read_b64_tr_b16 v[166:167], v193 offset:33792
  v_mfma_f32_32x32x16_bf16 v[112:127], v[132:135], v[140:143], v[112:127]
  v_mfma_f32_32x32x16_bf16 v[64:79], v[144:147], v[152:155], v[64:79]
  ds_read_b64_tr_b16 v[128:129], v192 offset:36864
  ds_read_b64_tr_b16 v[130:131], v192 offset:37888
  v_mfma_f32_32x32x16_bf16 v[80:95], v[144:147], v[156:159], v[80:95]
  ds_read_b128 v[136:139], v194 offset:33792
  ds_read_b128 v[140:143], v194 offset:37888
  v_mfma_f32_32x32x16_bf16 v[96:111], v[148:151], v[152:155], v[96:111]
  ds_read_b64_tr_b16 v[132:133], v193 offset:36864
  ds_read_b64_tr_b16 v[134:135], v193 offset:37888
  v_mfma_f32_32x32x16_bf16 v[112:127], v[148:151], v[156:159], v[112:127]
  s_waitcnt lgkmcnt(6)
  v_mfma_f32_32x32x16_bf16 v[64:79], v[160:163], v[168:171], v[64:79]
  ds_read_b64_tr_b16 v[144:145], v192 offset:40960
  ds_read_b64_tr_b16 v[146:147], v192 offset:41984
  v_mfma_f32_32x32x16_bf16 v[80:95], v[160:163], v[172:175], v[80:95]
  ds_read_b128 v[152:155], v194 offset:34816
  ds_read_b128 v[156:159], v194 offset:38912
  v_mfma_f32_32x32x16_bf16 v[96:111], v[164:167], v[168:171], v[96:111]
  ds_read_b64_tr_b16 v[148:149], v193 offset:40960
  ds_read_b64_tr_b16 v[150:151], v193 offset:41984
  v_mfma_f32_32x32x16_bf16 v[112:127], v[164:167], v[172:175], v[112:127]
  s_waitcnt lgkmcnt(6)
  v_mfma_f32_32x32x16_bf16 v[64:79], v[128:131], v[136:139], v[64:79]
  ds_read_b64_tr_b16 v[160:161], v192 offset:45056
  ds_read_b64_tr_b16 v[162:163], v192 offset:46080
  v_mfma_f32_32x32x16_bf16 v[80:95], v[128:131], v[140:143], v[80:95]
  ds_read_b128 v[168:171], v194 offset:35840
  ds_read_b128 v[172:175], v194 offset:39936
  v_mfma_f32_32x32x16_bf16 v[96:111], v[132:135], v[136:139], v[96:111]
  ds_read_b64_tr_b16 v[164:165], v193 offset:45056
  ds_read_b64_tr_b16 v[166:167], v193 offset:46080
  v_mfma_f32_32x32x16_bf16 v[112:127], v[132:135], v[140:143], v[112:127]
  s_waitcnt lgkmcnt(0)
  s_barrier
  v_mfma_f32_32x32x16_bf16 v[64:79], v[144:147], v[152:155], v[64:79]
  ds_read_b64_tr_b16 v[128:129], v192 offset:0
  ds_read_b64_tr_b16 v[130:131], v192 offset:1024
  v_mfma_f32_32x32x16_bf16 v[80:95], v[144:147], v[156:159], v[80:95]
  ds_read_b128 v[136:139], v194 offset:0
  ds_read_b128 v[140:143], v194 offset:4096
  v_mfma_f32_32x32x16_bf16 v[96:111], v[148:151], v[152:155], v[96:111]
  ds_read_b64_tr_b16 v[132:133], v193 offset:0
  ds_read_b64_tr_b16 v[134:135], v193 offset:1024
  v_mfma_f32_32x32x16_bf16 v[112:127], v[148:151], v[156:159], v[112:127]
  v_mfma_f32_32x32x16_bf16 v[64:79], v[160:163], v[168:171], v[64:79]
  ds_read_b64_tr_b16 v[144:145], v192 offset:4096
  ds_read_b64_tr_b16 v[146:147], v192 offset:5120
  v_mfma_f32_32x32x16_bf16 v[80:95], v[160:163], v[172:175], v[80:95]
  ds_read_b128 v[152:155], v194 offset:1024
  ds_read_b128 v[156:159], v194 offset:5120
  v_mfma_f32_32x32x16_bf16 v[96:111], v[164:167], v[168:171], v[96:111]
  ds_read_b64_tr_b16 v[148:149], v193 offset:4096
  ds_read_b64_tr_b16 v[150:151], v193 offset:5120
  v_mfma_f32_32x32x16_bf16 v[112:127], v[164:167], v[172:175], v[112:127]
  s_waitcnt lgkmcnt(6)
  v_mfma_f32_32x32x16_bf16 v[64:79], v[128:131], v[136:139], v[64:79]
  ds_read_b64_tr_b16 v[160:161], v192 offset:8192
  ds_read_b64_tr_b16 v[162:163], v192 offset:9216
  v_mfma_f32_32x32x16_bf16 v[80:95], v[128:131], v[140:143], v[80:95]
  ds_read_b128 v[168:171], v194 offset:2048
  ds_read_b128 v[172:175], v194 offset:6144
  v_mfma_f32_32x32x16_bf16 v[96:111], v[132:135], v[136:139], v[96:111]
  ds_read_b64_tr_b16 v[164:165], v193 offset:8192
  ds_read_b64_tr_b16 v[166:167], v193 offset:9216
  v_mfma_f32_32x32x16_bf16 v[112:127], v[132:135], v[140:143], v[112:127]
  s_waitcnt lgkmcnt(6)
  v_mfma_f32_32x32x16_bf16 v[64:79], v[144:147], v[152:155], v[64:79]
  ds_read_b64_tr_b16 v[128:129], v192 offset:12288
  ds_read_b64_tr_b16 v[130:131], v192 offset:13312
  v_mfma_f32_32x32x16_bf16 v[80:95], v[144:147], v[156:159], v[80:95]
  ds_read_b128 v[136:139], v194 offset:3072
  ds_read_b128 v[140:143], v194 offset:7168
  v_mfma_f32_32x32x16_bf16 v[96:111], v[148:151], v[152:155], v[96:111]
  ds_read_b64_tr_b16 v[132:133], v193 offset:12288
  ds_read_b64_tr_b16 v[134:135], v193 offset:13312
  v_mfma_f32_32x32x16_bf16 v[112:127], v[148:151], v[156:159], v[112:127]
  s_waitcnt lgkmcnt(0)
  s_barrier
  v_mfma_f32_32x32x16_bf16 v[64:79], v[160:163], v[168:171], v[64:79]
  ds_read_b64_tr_b16 v[144:145], v192 offset:16384
  ds_read_b64_tr_b16 v[146:147], v192 offset:17408
  v_mfma_f32_32x32x16_bf16 v[80:95], v[160:163], v[172:175], v[80:95]
  ds_read_b128 v[152:155], v194 offset:16384
  ds_read_b128 v[156:159], v194 offset:20480
  v_mfma_f32_32x32x16_bf16 v[96:111], v[164:167], v[168:171], v[96:111]
  ds_read_b64_tr_b16 v[148:149], v193 offset:16384
  ds_read_b64_tr_b16 v[150:151], v193 offset:17408
  v_mfma_f32_32x32x16_bf16 v[112:127], v[164:167], v[172:175], v[112:127]
  v_mfma_f32_32x32x16_bf16 v[64:79], v[128:131], v[136:139], v[64:79]
  ds_read_b64_tr_b16 v[160:161], v192 offset:20480
  ds_read_b64_tr_b16 v[162:163], v192 offset:21504
  v_mfma_f32_32x32x16_bf16 v[80:95], v[128:131], v[140:143], v[80:95]
  ds_read_b128 v[168:171], v194 offset:17408
  ds_read_b128 v[172:175], v194 offset:21504
  v_mfma_f32_32x32x16_bf16 v[96:111], v[132:135], v[136:139], v[96:111]
  ds_read_b64_tr_b16 v[164:165], v193 offset:20480
  ds_read_b64_tr_b16 v[166:167], v193 offset:21504
  v_mfma_f32_32x32x16_bf16 v[112:127], v[132:135], v[140:143], v[112:127]
  s_waitcnt lgkmcnt(6)
  v_mfma_f32_32x32x16_bf16 v[64:79], v[144:147], v[152:155], v[64:79]
  ds_read_b64_tr_b16 v[128:129], v192 offset:24576
  ds_read_b64_tr_b16 v[130:131], v192 offset:25600
  v_mfma_f32_32x32x16_bf16 v[80:95], v[144:147], v[156:159], v[80:95]
  ds_read_b128 v[136:139], v194 offset:18432
  ds_read_b128 v[140:143], v194 offset:22528
  v_mfma_f32_32x32x16_bf16 v[96:111], v[148:151], v[152:155], v[96:111]
  ds_read_b64_tr_b16 v[132:133], v193 offset:24576
  ds_read_b64_tr_b16 v[134:135], v193 offset:25600
  v_mfma_f32_32x32x16_bf16 v[112:127], v[148:151], v[156:159], v[112:127]
  s_waitcnt lgkmcnt(6)
  v_mfma_f32_32x32x16_bf16 v[64:79], v[160:163], v[168:171], v[64:79]
  ds_read_b64_tr_b16 v[144:145], v192 offset:28672
  ds_read_b64_tr_b16 v[146:147], v192 offset:29696
  v_mfma_f32_32x32x16_bf16 v[80:95], v[160:163], v[172:175], v[80:95]
  ds_read_b128 v[152:155], v194 offset:19456
  ds_read_b128 v[156:159], v194 offset:23552
  v_mfma_f32_32x32x16_bf16 v[96:111], v[164:167], v[168:171], v[96:111]
  ds_read_b64_tr_b16 v[148:149], v193 offset:28672
  ds_read_b64_tr_b16 v[150:151], v193 offset:29696
  v_mfma_f32_32x32x16_bf16 v[112:127], v[164:167], v[172:175], v[112:127]
  s_waitcnt lgkmcnt(0)
  s_barrier
  v_mfma_f32_32x32x16_bf16 v[64:79], v[128:131], v[136:139], v[64:79]
  ds_read_b64_tr_b16 v[160:161], v192 offset:32768
  ds_read_b64_tr_b16 v[162:163], v192 offset:33792
  v_mfma_f32_32x32x16_bf16 v[80:95], v[128:131], v[140:143], v[80:95]
  ds_read_b128 v[168:171], v194 offset:32768
  ds_read_b128 v[172:175], v194 offset:36864
  v_mfma_f32_32x32x16_bf16 v[96:111], v[132:135], v[136:139], v[96:111]
  ds_read_b64_tr_b16 v[164:165], v193 offset:32768
  ds_read_b64_tr_b16 v[166:167], v193 offset:33792
  v_mfma_f32_32x32x16_bf16 v[112:127], v[132:135], v[140:143], v[112:127]
  v_mfma_f32_32x32x16_bf16 v[64:79], v[144:147], v[152:155], v[64:79]
  ds_read_b64_tr_b16 v[128:129], v192 offset:36864
  ds_read_b64_tr_b16 v[130:131], v192 offset:37888
  v_mfma_f32_32x32x16_bf16 v[80:95], v[144:147], v[156:159], v[80:95]
  ds_read_b128 v[136:139], v194 offset:33792
  ds_read_b128 v[140:143], v194 offset:37888
  v_mfma_f32_32x32x16_bf16 v[96:111], v[148:151], v[152:155], v[96:111]
  ds_read_b64_tr_b16 v[132:133], v193 offset:36864
  ds_read_b64_tr_b16 v[134:135], v193 offset:37888
  v_mfma_f32_32x32x16_bf16 v[112:127], v[148:151], v[156:159], v[112:127]
  s_waitcnt lgkmcnt(6)
  v_mfma_f32_32x32x16_bf16 v[64:79], v[160:163], v[168:171], v[64:79]
  ds_read_b64_tr_b16 v[144:145], v192 offset:40960
  ds_read_b64_tr_b16 v[146:147], v192 offset:41984
  v_mfma_f32_32x32x16_bf16 v[80:95], v[160:163], v[172:175], v[80:95]
  ds_read_b128 v[152:155], v194 offset:34816
  ds_read_b128 v[156:159], v194 offset:38912
  v_mfma_f32_32x32x16_bf16 v[96:111], v[164:167], v[168:171], v[96:111]
  ds_read_b64_tr_b16 v[148:149], v193 offset:40960
  ds_read_b64_tr_b16 v[150:151], v193 offset:41984
  v_mfma_f32_32x32x16_bf16 v[112:127], v[164:167], v[172:175], v[112:127]
  s_waitcnt lgkmcnt(6)
  v_mfma_f32_32x32x16_bf16 v[64:79], v[128:131], v[136:139], v[64:79]
  ds_read_b64_tr_b16 v[160:161], v192 offset:45056
  ds_read_b64_tr_b16 v[162:163], v192 offset:46080
  v_mfma_f32_32x32x16_bf16 v[80:95], v[128:131], v[140:143], v[80:95]
  ds_read_b128 v[168:171], v194 offset:35840
  ds_read_b128 v[172:175], v194 offset:39936
  v_mfma_f32_32x32x16_bf16 v[96:111], v[132:135], v[136:139], v[96:111]
  ds_read_b64_tr_b16 v[164:165], v193 offset:45056
  ds_read_b64_tr_b16 v[166:167], v193 offset:46080
  v_mfma_f32_32x32x16_bf16 v[112:127], v[132:135], v[140:143], v[112:127]
  s_waitcnt lgkmcnt(0)
  s_barrier
  v_mfma_f32_32x32x16_bf16 v[64:79], v[144:147], v[152:155], v[64:79]
  ds_read_b64_tr_b16 v[128:129], v192 offset:0
  ds_read_b64_tr_b16 v[130:131], v192 offset:1024
  v_mfma_f32_32x32x16_bf16 v[80:95], v[144:147], v[156:159], v[80:95]
  ds_read_b128 v[136:139], v194 offset:0
  ds_read_b128 v[140:143], v194 offset:4096
  v_mfma_f32_32x32x16_bf16 v[96:111], v[148:151], v[152:155], v[96:111]
  ds_read_b64_tr_b16 v[132:133], v193 offset:0
  ds_read_b64_tr_b16 v[134:135], v193 offset:1024
  v_mfma_f32_32x32x16_bf16 v[112:127], v[148:151], v[156:159], v[112:127]
  v_mfma_f32_32x32x16_bf16 v[64:79], v[160:163], v[168:171], v[64:79]
  ds_read_b64_tr_b16 v[144:145], v192 offset:4096
  ds_read_b64_tr_b16 v[146:147], v192 offset:5120
  v_mfma_f32_32x32x16_bf16 v[80:95], v[160:163], v[172:175], v[80:95]
  ds_read_b128 v[152:155], v194 offset:1024
  ds_read_b128 v[156:159], v194 offset:5120
  v_mfma_f32_32x32x16_bf16 v[96:111], v[164:167], v[168:171], v[96:111]
  ds_read_b64_tr_b16 v[148:149], v193 offset:4096
  ds_read_b64_tr_b16 v[150:151], v193 offset:5120
  v_mfma_f32_32x32x16_bf16 v[112:127], v[164:167], v[172:175], v[112:127]
  s_waitcnt lgkmcnt(6)
  v_mfma_f32_32x32x16_bf16 v[64:79], v[128:131], v[136:139], v[64:79]
  ds_read_b64_tr_b16 v[160:161], v192 offset:8192
  ds_read_b64_tr_b16 v[162:163], v192 offset:9216
  v_mfma_f32_32x32x16_bf16 v[80:95], v[128:131], v[140:143], v[80:95]
  ds_read_b128 v[168:171], v194 offset:2048
  ds_read_b128 v[172:175], v194 offset:6144
  v_mfma_f32_32x32x16_bf16 v[96:111], v[132:135], v[136:139], v[96:111]
  ds_read_b64_tr_b16 v[164:165], v193 offset:8192
  ds_read_b64_tr_b16 v[166:167], v193 offset:9216
  v_mfma_f32_32x32x16_bf16 v[112:127], v[132:135], v[140:143], v[112:127]
  s_waitcnt lgkmcnt(6)
  v_mfma_f32_32x32x16_bf16 v[64:79], v[144:147], v[152:155], v[64:79]
  ds_read_b64_tr_b16 v[128:129], v192 offset:12288
  ds_read_b64_tr_b16 v[130:131], v192 offset:13312
  v_mfma_f32_32x32x16_bf16 v[80:95], v[144:147], v[156:159], v[80:95]
  ds_read_b128 v[136:139], v194 offset:3072
  ds_read_b128 v[140:143], v194 offset:7168
  v_mfma_f32_32x32x16_bf16 v[96:111], v[148:151], v[152:155], v[96:111]
  ds_read_b64_tr_b16 v[132:133], v193 offset:12288
  ds_read_b64_tr_b16 v[134:135], v193 offset:13312
  v_mfma_f32_32x32x16_bf16 v[112:127], v[148:151], v[156:159], v[112:127]
  s_waitcnt lgkmcnt(0)
  s_barrier
  v_mfma_f32_32x32x16_bf16 v[64:79], v[160:163], v[168:171], v[64:79]
  ds_read_b64_tr_b16 v[144:145], v192 offset:16384
  ds_read_b64_tr_b16 v[146:147], v192 offset:17408
  v_mfma_f32_32x32x16_bf16 v[80:95], v[160:163], v[172:175], v[80:95]
  ds_read_b128 v[152:155], v194 offset:16384
  ds_read_b128 v[156:159], v194 offset:20480
  v_mfma_f32_32x32x16_bf16 v[96:111], v[164:167], v[168:171], v[96:111]
  ds_read_b64_tr_b16 v[148:149], v193 offset:16384
  ds_read_b64_tr_b16 v[150:151], v193 offset:17408
  v_mfma_f32_32x32x16_bf16 v[112:127], v[164:167], v[172:175], v[112:127]
  v_mfma_f32_32x32x16_bf16 v[64:79], v[128:131], v[136:139], v[64:79]
  ds_read_b64_tr_b16 v[160:161], v192 offset:20480
  ds_read_b64_tr_b16 v[162:163], v192 offset:21504
  v_mfma_f32_32x32x16_bf16 v[80:95], v[128:131], v[140:143], v[80:95]
  ds_read_b128 v[168:171], v194 offset:17408
  ds_read_b128 v[172:175], v194 offset:21504
  v_mfma_f32_32x32x16_bf16 v[96:111], v[132:135], v[136:139], v[96:111]
  ds_read_b64_tr_b16 v[164:165], v193 offset:20480
  ds_read_b64_tr_b16 v[166:167], v193 offset:21504
  v_mfma_f32_32x32x16_bf16 v[112:127], v[132:135], v[140:143], v[112:127]
  s_waitcnt lgkmcnt(6)
  v_mfma_f32_32x32x16_bf16 v[64:79], v[144:147], v[152:155], v[64:79]
  ds_read_b64_tr_b16 v[128:129], v192 offset:24576
  ds_read_b64_tr_b16 v[130:131], v192 offset:25600
  v_mfma_f32_32x32x16_bf16 v[80:95], v[144:147], v[156:159], v[80:95]
  ds_read_b128 v[136:139], v194 offset:18432
  ds_read_b128 v[140:143], v194 offset:22528
  v_mfma_f32_32x32x16_bf16 v[96:111], v[148:151], v[152:155], v[96:111]
  ds_read_b64_tr_b16 v[132:133], v193 offset:24576
  ds_read_b64_tr_b16 v[134:135], v193 offset:25600
  v_mfma_f32_32x32x16_bf16 v[112:127], v[148:151], v[156:159], v[112:127]
  s_waitcnt lgkmcnt(6)
  v_mfma_f32_32x32x16_bf16 v[64:79], v[160:163], v[168:171], v[64:79]
  ds_read_b64_tr_b16 v[144:145], v192 offset:28672
  ds_read_b64_tr_b16 v[146:147], v192 offset:29696
  v_mfma_f32_32x32x16_bf16 v[80:95], v[160:163], v[172:175], v[80:95]
  ds_read_b128 v[152:155], v194 offset:19456
  ds_read_b128 v[156:159], v194 offset:23552
  v_mfma_f32_32x32x16_bf16 v[96:111], v[164:167], v[168:171], v[96:111]
  ds_read_b64_tr_b16 v[148:149], v193 offset:28672
  ds_read_b64_tr_b16 v[150:151], v193 offset:29696
  v_mfma_f32_32x32x16_bf16 v[112:127], v[164:167], v[172:175], v[112:127]
  s_waitcnt lgkmcnt(0)
  s_barrier
  v_mfma_f32_32x32x16_bf16 v[64:79], v[128:131], v[136:139], v[64:79]
  ds_read_b64_tr_b16 v[160:161], v192 offset:32768
  ds_read_b64_tr_b16 v[162:163], v192 offset:33792
  v_mfma_f32_32x32x16_bf16 v[80:95], v[128:131], v[140:143], v[80:95]
  ds_read_b128 v[168:171], v194 offset:32768
  ds_read_b128 v[172:175], v194 offset:36864
  v_mfma_f32_32x32x16_bf16 v[96:111], v[132:135], v[136:139], v[96:111]
  ds_read_b64_tr_b16 v[164:165], v193 offset:32768
  ds_read_b64_tr_b16 v[166:167], v193 offset:33792
  v_mfma_f32_32x32x16_bf16 v[112:127], v[132:135], v[140:143], v[112:127]
  v_mfma_f32_32x32x16_bf16 v[64:79], v[144:147], v[152:155], v[64:79]
  ds_read_b64_tr_b16 v[128:129], v192 offset:36864
  ds_read_b64_tr_b16 v[130:131], v192 offset:37888
  v_mfma_f32_32x32x16_bf16 v[80:95], v[144:147], v[156:159], v[80:95]
  ds_read_b128 v[136:139], v194 offset:33792
  ds_read_b128 v[140:143], v194 offset:37888
  v_mfma_f32_32x32x16_bf16 v[96:111], v[148:151], v[152:155], v[96:111]
  ds_read_b64_tr_b16 v[132:133], v193 offset:36864
  ds_read_b64_tr_b16 v[134:135], v193 offset:37888
  v_mfma_f32_32x32x16_bf16 v[112:127], v[148:151], v[156:159], v[112:127]
  s_waitcnt lgkmcnt(6)
  v_mfma_f32_32x32x16_bf16 v[64:79], v[160:163], v[168:171], v[64:79]
  ds_read_b64_tr_b16 v[144:145], v192 offset:40960
  ds_read_b64_tr_b16 v[146:147], v192 offset:41984
  v_mfma_f32_32x32x16_bf16 v[80:95], v[160:163], v[172:175], v[80:95]
  ds_read_b128 v[152:155], v194 offset:34816
  ds_read_b128 v[156:159], v194 offset:38912
  v_mfma_f32_32x32x16_bf16 v[96:111], v[164:167], v[168:171], v[96:111]
  ds_read_b64_tr_b16 v[148:149], v193 offset:40960
  ds_read_b64_tr_b16 v[150:151], v193 offset:41984
  v_mfma_f32_32x32x16_bf16 v[112:127], v[164:167], v[172:175], v[112:127]
  s_waitcnt lgkmcnt(6)
  v_mfma_f32_32x32x16_bf16 v[64:79], v[128:131], v[136:139], v[64:79]
  ds_read_b64_tr_b16 v[160:161], v192 offset:45056
  ds_read_b64_tr_b16 v[162:163], v192 offset:46080
  v_mfma_f32_32x32x16_bf16 v[80:95], v[128:131], v[140:143], v[80:95]
  ds_read_b128 v[168:171], v194 offset:35840
  ds_read_b128 v[172:175], v194 offset:39936
  v_mfma_f32_32x32x16_bf16 v[96:111], v[132:135], v[136:139], v[96:111]
  ds_read_b64_tr_b16 v[164:165], v193 offset:45056
  ds_read_b64_tr_b16 v[166:167], v193 offset:46080
  v_mfma_f32_32x32x16_bf16 v[112:127], v[132:135], v[140:143], v[112:127]
  s_waitcnt lgkmcnt(0)
  s_barrier
  v_mfma_f32_32x32x16_bf16 v[64:79], v[144:147], v[152:155], v[64:79]
  ds_read_b64_tr_b16 v[128:129], v192 offset:0
  ds_read_b64_tr_b16 v[130:131], v192 offset:1024
  v_mfma_f32_32x32x16_bf16 v[80:95], v[144:147], v[156:159], v[80:95]
  ds_read_b128 v[136:139], v194 offset:0
  ds_read_b128 v[140:143], v194 offset:4096
  v_mfma_f32_32x32x16_bf16 v[96:111], v[148:151], v[152:155], v[96:111]
  ds_read_b64_tr_b16 v[132:133], v193 offset:0
  ds_read_b64_tr_b16 v[134:135], v193 offset:1024
  v_mfma_f32_32x32x16_bf16 v[112:127], v[148:151], v[156:159], v[112:127]
  v_mfma_f32_32x32x16_bf16 v[64:79], v[160:163], v[168:171], v[64:79]
  ds_read_b64_tr_b16 v[144:145], v192 offset:4096
  ds_read_b64_tr_b16 v[146:147], v192 offset:5120
  v_mfma_f32_32x32x16_bf16 v[80:95], v[160:163], v[172:175], v[80:95]
  ds_read_b128 v[152:155], v194 offset:1024
  ds_read_b128 v[156:159], v194 offset:5120
  v_mfma_f32_32x32x16_bf16 v[96:111], v[164:167], v[168:171], v[96:111]
  ds_read_b64_tr_b16 v[148:149], v193 offset:4096
  ds_read_b64_tr_b16 v[150:151], v193 offset:5120
  v_mfma_f32_32x32x16_bf16 v[112:127], v[164:167], v[172:175], v[112:127]
  s_waitcnt lgkmcnt(6)
  v_mfma_f32_32x32x16_bf16 v[64:79], v[128:131], v[136:139], v[64:79]
  ds_read_b64_tr_b16 v[160:161], v192 offset:8192
  ds_read_b64_tr_b16 v[162:163], v192 offset:9216
  v_mfma_f32_32x32x16_bf16 v[80:95], v[128:131], v[140:143], v[80:95]
  ds_read_b128 v[168:171], v194 offset:2048
  ds_read_b128 v[172:175], v194 offset:6144
  v_mfma_f32_32x32x16_bf16 v[96:111], v[132:135], v[136:139], v[96:111]
  ds_read_b64_tr_b16 v[164:165], v193 offset:8192
  ds_read_b64_tr_b16 v[166:167], v193 offset:9216
  v_mfma_f32_32x32x16_bf16 v[112:127], v[132:135], v[140:143], v[112:127]
  s_waitcnt lgkmcnt(6)
  v_mfma_f32_32x32x16_bf16 v[64:79], v[144:147], v[152:155], v[64:79]
  ds_read_b64_tr_b16 v[128:129], v192 offset:12288
  ds_read_b64_tr_b16 v[130:131], v192 offset:13312
  v_mfma_f32_32x32x16_bf16 v[80:95], v[144:147], v[156:159], v[80:95]
  ds_read_b128 v[136:139], v194 offset:3072
  ds_read_b128 v[140:143], v194 offset:7168
  v_mfma_f32_32x32x16_bf16 v[96:111], v[148:151], v[152:155], v[96:111]
  ds_read_b64_tr_b16 v[132:133], v193 offset:12288
  ds_read_b64_tr_b16 v[134:135], v193 offset:13312
  v_mfma_f32_32x32x16_bf16 v[112:127], v[148:151], v[156:159], v[112:127]
  s_waitcnt lgkmcnt(0)
  s_barrier
  v_mfma_f32_32x32x16_bf16 v[64:79], v[160:163], v[168:171], v[64:79]
  v_mfma_f32_32x32x16_bf16 v[80:95], v[160:163], v[172:175], v[80:95]
  v_mfma_f32_32x32x16_bf16 v[96:111], v[164:167], v[168:171], v[96:111]
  v_mfma_f32_32x32x16_bf16 v[112:127], v[164:167], v[172:175], v[112:127]
  v_mfma_f32_32x32x16_bf16 v[64:79], v[128:131], v[136:139], v[64:79]
  v_mfma_f32_32x32x16_bf16 v[80:95], v[128:131], v[140:143], v[80:95]
  v_mfma_f32_32x32x16_bf16 v[96:111], v[132:135], v[136:139], v[96:111]
  v_mfma_f32_32x32x16_bf16 v[112:127], v[132:135], v[140:143], v[112:127]
  s_nop 7
  s_nop 3
  s_cmp_eq_u32 s27, 0
  s_cbranch_scc1 L_SK0
  s_add_u32 s54, s66, 0
  v_cvt_pk_bf16_f32 v144, v64, v65
  v_cvt_pk_bf16_f32 v145, v66, v67
  v_cvt_pk_bf16_f32 v146, v68, v69
  v_cvt_pk_bf16_f32 v147, v70, v71
  v_cvt_pk_bf16_f32 v148, v72, v73
  v_cvt_pk_bf16_f32 v149, v74, v75
  v_cvt_pk_bf16_f32 v150, v76, v77
  v_cvt_pk_bf16_f32 v151, v78, v79
  buffer_store_dwordx4 v[144:147], v41, s[44:47], s54 offen offset:0 sc1
  buffer_store_dwordx4 v[148:151], v41, s[44:47], s54 offen offset:1024 sc1
  s_branch L_SN0
L_SK0:
  v_mov_b32 v128, v64
  v_mov_b32 v129, v65
  v_mov_b32 v130, v66
  v_mov_b32 v131, v67
  v_mov_b32 v132, v68
  v_mov_b32 v133, v69
  v_mov_b32 v134, v70
  v_mov_b32 v135, v71
  v_mov_b32 v136, v72
  v_mov_b32 v137, v73
  v_mov_b32 v138, v74
  v_mov_b32 v139, v75
  v_mov_b32 v140, v76
  v_mov_b32 v141, v77
  v_mov_b32 v142, v78
  v_mov_b32 v143, v79
L_SN0:
  s_cmp_eq_u32 s27, 1
  s_cbranch_scc1 L_SK1
  s_add_u32 s54, s66, 65536
  v_cvt_pk_bf16_f32 v152, v80, v81
  v_cvt_pk_bf16_f32 v153, v82, v83
  v_cvt_pk_bf16_f32 v154, v84, v85
  v_cvt_pk_bf16_f32 v155, v86, v87
  v_cvt_pk_bf16_f32 v156, v88, v89
  v_cvt_pk_bf16_f32 v157, v90, v91
  v_cvt_pk_bf16_f32 v158, v92, v93
  v_cvt_pk_bf16_f32 v159, v94, v95
  buffer_store_dwordx4 v[152:155], v41, s[44:47], s54 offen offset:0 sc1
  buffer_store_dwordx4 v[156:159], v41, s[44:47], s54 offen offset:1024 sc1
  s_branch L_SN1
L_SK1:
  v_mov_b32 v128, v80
  v_mov_b32 v129, v81
  v_mov_b32 v130, v82
  v_mov_b32 v131, v83
  v_mov_b32 v132, v84
  v_mov_b32 v133, v85
  v_mov_b32 v134, v86
  v_mov_b32 v135, v87
  v_mov_b32 v136, v88
  v_mov_b32 v137, v89
  v_mov_b32 v138, v90
  v_mov_b32 v139, v91
  v_mov_b32 v140, v92
  v_mov_b32 v141, v93
  v_mov_b32 v142, v94
  v_mov_b32 v143, v95
L_SN1:
  s_cmp_eq_u32 s27, 2
  s_cbranch_scc1 L_SK2
  s_add_u32 s54, s66, 131072
  v_cvt_pk_bf16_f32 v160, v96, v97
  v_cvt_pk_bf16_f32 v161, v98, v99
  v_cvt_pk_bf16_f32 v162, v100, v101
  v_cvt_pk_bf16_f32 v163, v102, v103
  v_cvt_pk_bf16_f32 v164, v104, v105
  v_cvt_pk_bf16_f32 v165, v106, v107
  v_cvt_pk_bf16_f32 v166, v108, v109
  v_cvt_pk_bf16_f32 v167, v110, v111
  buffer_store_dwordx4 v[160:163], v41, s[44:47], s54 offen offset:0 sc1
  buffer_store_dwordx4 v[164:167], v41, s[44:47], s54 offen offset:1024 sc1
  s_branch L_SN2
L_SK2:
  v_mov_b32 v128, v96
  v_mov_b32 v129, v97
  v_mov_b32 v130, v98
  v_mov_b32 v131, v99
  v_mov_b32 v132, v100
  v_mov_b32 v133, v101
  v_mov_b32 v134, v102
  v_mov_b32 v135, v103
  v_mov_b32 v136, v104
  v_mov_b32 v137, v105
  v_mov_b32 v138, v106
  v_mov_b32 v139, v107
  v_mov_b32 v140, v108
  v_mov_b32 v141, v109
  v_mov_b32 v142, v110
  v_mov_b32 v143, v111
L_SN2:
  s_cmp_eq_u32 s27, 3
  s_cbranch_scc1 L_SK3
  s_add_u32 s54, s66, 196608
  v_cvt_pk_bf16_f32 v168, v112, v113
  v_cvt_pk_bf16_f32 v169, v114, v115
  v_cvt_pk_bf16_f32 v170, v116, v117
  v_cvt_pk_bf16_f32 v171, v118, v119
  v_cvt_pk_bf16_f32 v172, v120, v121
  v_cvt_pk_bf16_f32 v173, v122, v123
  v_cvt_pk_bf16_f32 v174, v124, v125
  v_cvt_pk_bf16_f32 v175, v126, v127
  buffer_store_dwordx4 v[168:171], v41, s[44:47], s54 offen offset:0 sc1
  buffer_store_dwordx4 v[172:175], v41, s[44:47], s54 offen offset:1024 sc1
  s_branch L_SN3
L_SK3:
  v_mov_b32 v128, v112
  v_mov_b32 v129, v113
  v_mov_b32 v130, v114
  v_mov_b32 v131, v115
  v_mov_b32 v132, v116
  v_mov_b32 v133, v117
  v_mov_b32 v134, v118
  v_mov_b32 v135, v119
  v_mov_b32 v136, v120
  v_mov_b32 v137, v121
  v_mov_b32 v138, v122
  v_mov_b32 v139, v123
  v_mov_b32 v140, v124
  v_mov_b32 v141, v125
  v_mov_b32 v142, v126
  v_mov_b32 v143, v127
L_SN3:
  s_waitcnt vmcnt(0)
  v_lshlrev_b32 v1, 7, v0
  s_lshl_b32 s55, s20, 5
  v_add_u32 v1, s55, v1
  v_mov_b32 v2, s74
  s_lshl_b32 s54, s27, 7
  v_cmp_eq_u32 vcc, 0, v0
  s_and_saveexec_b64 s[68:69], vcc
  buffer_store_dword v2, v1, s[40:43], s54 offen sc1
  s_mov_b64 exec, s[68:69]
  v_cmp_gt_u32 vcc, 4, v0
  s_and_saveexec_b64 s[68:69], vcc
  s_mov_b32 s55, 0
L_XP:
  buffer_load_dword v3, v1, s[40:43], 0 offen sc1
  s_add_u32 s55, s55, 1
  s_waitcnt vmcnt(0)
  v_cmp_eq_u32 vcc, s74, v3
  s_cmp_eq_u32 vcc_lo, 15
  s_cbranch_scc1 L_XP_OK
  s_sleep 2
  s_cmp_lt_u32 s55, 0x40000
  s_cbranch_scc1 L_XP
L_XP_OK:
  s_mov_b64 exec, s[68:69]
  s_cmp_eq_u32 s27, 0
  s_cbranch_scc1 L_LK0
  s_lshl_b32 s54, s27, 16
  s_add_u32 s54, s54, 0
  buffer_load_dwordx4 v[64:67], v41, s[44:47], s54 offen offset:0 sc1
  buffer_load_dwordx4 v[68:71], v41, s[44:47], s54 offen offset:1024 sc1
  s_branch L_LN0
L_LK0:
  v_mov_b32 v64, 0
  v_mov_b32 v65, 0
  v_mov_b32 v66, 0
  v_mov_b32 v67, 0
  v_mov_b32 v68, 0
  v_mov_b32 v69, 0
  v_mov_b32 v70, 0
  v_mov_b32 v71, 0
L_LN0:
  s_cmp_eq_u32 s27, 1
  s_cbranch_scc1 L_LK1
  s_lshl_b32 s54, s27, 16
  s_add_u32 s54, s54, 16384
  buffer_load_dwordx4 v[72:75], v41, s[44:47], s54 offen offset:0 sc1
  buffer_load_dwordx4 v[76:79], v41, s[44:47], s54 offen offset:1024 sc1
  s_branch L_LN1
L_LK1:
  v_mov_b32 v72, 0
  v_mov_b32 v73, 0
  v_mov_b32 v74, 0
  v_mov_b32 v75, 0
  v_mov_b32 v76, 0
  v_mov_b32 v77, 0
  v_mov_b32 v78, 0
  v_mov_b32 v79, 0
L_LN1:
  s_cmp_eq_u32 s27, 2
  s_cbranch_scc1 L_LK2
  s_lshl_b32 s54, s27, 16
  s_add_u32 s54, s54, 32768
  buffer_load_dwordx4 v[80:83], v41, s[44:47], s54 offen offset:0 sc1
  buffer_load_dwordx4 v[84:87], v41, s[44:47], s54 offen offset:1024 sc1
  s_branch L_LN2
L_LK2:
  v_mov_b32 v80, 0
  v_mov_b32 v81, 0
  v_mov_b32 v82, 0
  v_mov_b32 v83, 0
  v_mov_b32 v84, 0
  v_mov_b32 v85, 0
  v_mov_b32 v86, 0
  v_mov_b32 v87, 0
L_LN2:
  s_cmp_eq_u32 s27, 3
  s_cbranch_scc1 L_LK3
  s_lshl_b32 s54, s27, 16
  s_add_u32 s54, s54, 49152
  buffer_load_dwordx4 v[88:91], v41, s[44:47], s54 offen offset:0 sc1
  buffer_load_dwordx4 v[92:95], v41, s[44:47], s54 offen offset:1024 sc1
  s_branch L_LN3
L_LK3:
  v_mov_b32 v88, 0
  v_mov_b32 v89, 0
  v_mov_b32 v90, 0
  v_mov_b32 v91, 0
  v_mov_b32 v92, 0
  v_mov_b32 v93, 0
  v_mov_b32 v94, 0
  v_mov_b32 v95, 0
L_LN3:
  s_waitcnt vmcnt(0)
  v_lshlrev_b32 v96, 16, v64
  v_and_b32 v97, 0xffff0000, v64
  v_lshlrev_b32 v98, 16, v65
  v_and_b32 v99, 0xffff0000, v65
  v_lshlrev_b32 v100, 16, v66
  v_and_b32 v101, 0xffff0000, v66
  v_lshlrev_b32 v102, 16, v67
  v_and_b32 v103, 0xffff0000, v67
  v_lshlrev_b32 v104, 16, v68
  v_and_b32 v105, 0xffff0000, v68
  v_lshlrev_b32 v106, 16, v69
  v_and_b32 v107, 0xffff0000, v69
  v_lshlrev_b32 v108, 16, v70
  v_and_b32 v109, 0xffff0000, v70
  v_lshlrev_b32 v110, 16, v71
  v_and_b32 v111, 0xffff0000, v71
  v_add_f32 v128, v128, v96
  v_add_f32 v129, v129, v97
  v_add_f32 v130, v130, v98
  v_add_f32 v131, v131, v99
  v_add_f32 v132, v132, v100
  v_add_f32 v133, v133, v101
  v_add_f32 v134, v134, v102
  v_add_f32 v135, v135, v103
  v_add_f32 v136, v136, v104
  v_add_f32 v137, v137, v105
  v_add_f32 v138, v138, v106
  v_add_f32 v139, v139, v107
  v_add_f32 v140, v140, v108
  v_add_f32 v141, v141, v109
  v_add_f32 v142, v142, v110
  v_add_f32 v143, v143, v111
  v_lshlrev_b32 v96, 16, v72
  v_and_b32 v97, 0xffff0000, v72
  v_lshlrev_b32 v98, 16, v73
  v_and_b32 v99, 0xffff0000, v73
  v_lshlrev_b32 v100, 16, v74
  v_and_b32 v101, 0xffff0000, v74
  v_lshlrev_b32 v102, 16, v75
  v_and_b32 v103, 0xffff0000, v75
  v_lshlrev_b32 v104, 16, v76
  v_and_b32 v105, 0xffff0000, v76
  v_lshlrev_b32 v106, 16, v77
  v_and_b32 v107, 0xffff0000, v77
  v_lshlrev_b32 v108, 16, v78
  v_and_b32 v109, 0xffff0000, v78
  v_lshlrev_b32 v110, 16, v79
  v_and_b32 v111, 0xffff0000, v79
  v_add_f32 v128, v128, v96
  v_add_f32 v129, v129, v97
  v_add_f32 v130, v130, v98
  v_add_f32 v131, v131, v99
  v_add_f32 v132, v132, v100
  v_add_f32 v133, v133, v101
  v_add_f32 v134, v134, v102
  v_add_f32 v135, v135, v103
  v_add_f32 v136, v136, v104
  v_add_f32 v137, v137, v105
  v_add_f32 v138, v138, v106
  v_add_f32 v139, v139, v107
  v_add_f32 v140, v140, v108
  v_add_f32 v141, v141, v109
  v_add_f32 v142, v142, v110
  v_add_f32 v143, v143, v111
  v_lshlrev_b32 v96, 16, v80
  v_and_b32 v97, 0xffff0000, v80
  v_lshlrev_b32 v98, 16, v81
  v_and_b32 v99, 0xffff0000, v81
  v_lshlrev_b32 v100, 16, v82
  v_and_b32 v101, 0xffff0000, v82
  v_lshlrev_b32 v102, 16, v83
  v_and_b32 v103, 0xffff0000, v83
  v_lshlrev_b32 v104, 16, v84
  v_and_b32 v105, 0xffff0000, v84
  v_lshlrev_b32 v106, 16, v85
  v_and_b32 v107, 0xffff0000, v85
  v_lshlrev_b32 v108, 16, v86
  v_and_b32 v109, 0xffff0000, v86
  v_lshlrev_b32 v110, 16, v87
  v_and_b32 v111, 0xffff0000, v87
  v_add_f32 v128, v128, v96
  v_add_f32 v129, v129, v97
  v_add_f32 v130, v130, v98
  v_add_f32 v131, v131, v99
  v_add_f32 v132, v132, v100
  v_add_f32 v133, v133, v101
  v_add_f32 v134, v134, v102
  v_add_f32 v135, v135, v103
  v_add_f32 v136, v136, v104
  v_add_f32 v137, v137, v105
  v_add_f32 v138, v138, v106
  v_add_f32 v139, v139, v107
  v_add_f32 v140, v140, v108
  v_add_f32 v141, v141, v109
  v_add_f32 v142, v142, v110
  v_add_f32 v143, v143, v111
  v_lshlrev_b32 v96, 16, v88
  v_and_b32 v97, 0xffff0000, v88
  v_lshlrev_b32 v98, 16, v89
  v_and_b32 v99, 0xffff0000, v89
  v_lshlrev_b32 v100, 16, v90
  v_and_b32 v101, 0xffff0000, v90
  v_lshlrev_b32 v102, 16, v91
  v_and_b32 v103, 0xffff0000, v91
  v_lshlrev_b32 v104, 16, v92
  v_and_b32 v105, 0xffff0000, v92
  v_lshlrev_b32 v106, 16, v93
  v_and_b32 v107, 0xffff0000, v93
  v_lshlrev_b32 v108, 16, v94
  v_and_b32 v109, 0xffff0000, v94
  v_lshlrev_b32 v110, 16, v95
  v_and_b32 v111, 0xffff0000, v95
  v_add_f32 v128, v128, v96
  v_add_f32 v129, v129, v97
  v_add_f32 v130, v130, v98
  v_add_f32 v131, v131, v99
  v_add_f32 v132, v132, v100
  v_add_f32 v133, v133, v101
  v_add_f32 v134, v134, v102
  v_add_f32 v135, v135, v103
  v_add_f32 v136, v136, v104
  v_add_f32 v137, v137, v105
  v_add_f32 v138, v138, v106
  v_add_f32 v139, v139, v107
  v_add_f32 v140, v140, v108
  v_add_f32 v141, v141, v109
  v_add_f32 v142, v142, v110
  v_add_f32 v143, v143, v111
  v_cvt_pk_bf16_f32 v144, v128, v129
  v_cvt_pk_bf16_f32 v145, v130, v131
  v_cvt_pk_bf16_f32 v146, v132, v133
  v_cvt_pk_bf16_f32 v147, v134, v135
  v_cvt_pk_bf16_f32 v148, v136, v137
  v_cvt_pk_bf16_f32 v149, v138, v139
  v_cvt_pk_bf16_f32 v150, v140, v141
  v_cvt_pk_bf16_f32 v151, v142, v143
  buffer_store_dwordx4 v[144:147], v40, s[36:39], s78 offen offset:0
  buffer_store_dwordx4 v[148:151], v40, s[36:39], s78 offen offset:32
  s_endpgm
K1_RO1:
  v_max_f32 v8, 0, v8
  v_sub_f32 v12, 0, v8
  v_sub_f32 v208, v208, v8
  v_sub_f32 v209, v209, v8
  v_sub_f32 v210, v210, v8
  v_sub_f32 v211, v211, v8
  v_sub_f32 v212, v212, v8
  v_sub_f32 v213, v213, v8
  v_sub_f32 v214, v214, v8
  v_sub_f32 v215, v215, v8
  v_sub_f32 v216, v216, v8
  v_sub_f32 v217, v217, v8
  v_sub_f32 v218, v218, v8
  v_sub_f32 v219, v219, v8
  v_sub_f32 v220, v220, v8
  v_sub_f32 v221, v221, v8
  v_sub_f32 v222, v222, v8
  v_sub_f32 v223, v223, v8
  v_exp_f32 v12, v12
  v_sub_f32 v160, v160, v8
  v_sub_f32 v161, v161, v8
  v_sub_f32 v162, v162, v8
  v_sub_f32 v163, v163, v8
  v_sub_f32 v164, v164, v8
  v_sub_f32 v165, v165, v8
  v_sub_f32 v166, v166, v8
  v_sub_f32 v167, v167, v8
  v_sub_f32 v168, v168, v8
  v_sub_f32 v169, v169, v8
  v_sub_f32 v170, v170, v8
  v_sub_f32 v171, v171, v8
  v_sub_f32 v172, v172, v8
  v_sub_f32 v173, v173, v8
  v_sub_f32 v174, v174, v8
  v_sub_f32 v175, v175, v8
  v_sub_f32 v176, v176, v8
  v_sub_f32 v177, v177, v8
  v_sub_f32 v178, v178, v8
  v_sub_f32 v179, v179, v8
  v_sub_f32 v180, v180, v8
  v_sub_f32 v181, v181, v8
  v_sub_f32 v182, v182, v8
  v_sub_f32 v183, v183, v8
  v_sub_f32 v184, v184, v8
  v_sub_f32 v185, v185, v8
  v_sub_f32 v186, v186, v8
  v_sub_f32 v187, v187, v8
  v_sub_f32 v188, v188, v8
  v_sub_f32 v189, v189, v8
  v_sub_f32 v190, v190, v8
  v_sub_f32 v191, v191, v8
  v_mul_f32 v10, v12, v10
  v_mul_f32 v11, v12, v11
  s_mov_b32 s65, 1
  s_branch K1_R1
K1_SO2:
  s_nop 7
  s_nop 7
  v_mul_f32 v64, v12, v64
  v_mul_f32 v65, v12, v65
  v_mul_f32 v66, v12, v66
  v_mul_f32 v67, v12, v67
  v_mul_f32 v68, v12, v68
  v_mul_f32 v69, v12, v69
  v_mul_f32 v70, v12, v70
  v_mul_f32 v71, v12, v71
  v_mul_f32 v72, v12, v72
  v_mul_f32 v73, v12, v73
  v_mul_f32 v74, v12, v74
  v_mul_f32 v75, v12, v75
  v_mul_f32 v76, v12, v76
  v_mul_f32 v77, v12, v77
  v_mul_f32 v78, v12, v78
  v_mul_f32 v79, v12, v79
  v_mul_f32 v80, v12, v80
  v_mul_f32 v81, v12, v81
  v_mul_f32 v82, v12, v82
  v_mul_f32 v83, v12, v83
  v_mul_f32 v84, v12, v84
  v_mul_f32 v85, v12, v85
  v_mul_f32 v86, v12, v86
  v_mul_f32 v87, v12, v87
  v_mul_f32 v88, v12, v88
  v_mul_f32 v89, v12, v89
  v_mul_f32 v90, v12, v90
  v_mul_f32 v91, v12, v91
  v_mul_f32 v92, v12, v92
  v_mul_f32 v93, v12, v93
  v_mul_f32 v94, v12, v94
  v_mul_f32 v95, v12, v95
  v_mul_f32 v96, v12, v96
  v_mul_f32 v97, v12, v97
  v_mul_f32 v98, v12, v98
  v_mul_f32 v99, v12, v99
  v_mul_f32 v100, v12, v100
  v_mul_f32 v101, v12, v101
  v_mul_f32 v102, v12, v102
  v_mul_f32 v103, v12, v103
  v_mul_f32 v104, v12, v104
  v_mul_f32 v105, v12, v105
  v_mul_f32 v106, v12, v106
  v_mul_f32 v107, v12, v107
  v_mul_f32 v108, v12, v108
  v_mul_f32 v109, v12, v109
  v_mul_f32 v110, v12, v110
  v_mul_f32 v111, v12, v111
  v_mul_f32 v112, v12, v112
  v_mul_f32 v113, v12, v113
  v_mul_f32 v114, v12, v114
  v_mul_f32 v115, v12, v115
  v_mul_f32 v116, v12, v116
  v_mul_f32 v117, v12, v117
  v_mul_f32 v118, v12, v118
  v_mul_f32 v119, v12, v119
  v_mul_f32 v120, v12, v120
  v_mul_f32 v121, v12, v121
  v_mul_f32 v122, v12, v122
  v_mul_f32 v123, v12, v123
  v_mul_f32 v124, v12, v124
  v_mul_f32 v125, v12, v125
  v_mul_f32 v126, v12, v126
  v_mul_f32 v127, v12, v127
  s_nop 1
  s_branch K1_S2
K1_RO2:
  v_max_f32 v8, 0, v8
  v_sub_f32 v12, 0, v8
  v_sub_f32 v208, v208, v8
  v_sub_f32 v209, v209, v8
  v_sub_f32 v210, v210, v8
  v_sub_f32 v211, v211, v8
  v_sub_f32 v212, v212, v8
  v_sub_f32 v213, v213, v8
  v_sub_f32 v214, v214, v8
  v_sub_f32 v215, v215, v8
  v_sub_f32 v216, v216, v8
  v_sub_f32 v217, v217, v8
  v_sub_f32 v218, v218, v8
  v_sub_f32 v219, v219, v8
  v_sub_f32 v220, v220, v8
  v_sub_f32 v221, v221, v8
  v_sub_f32 v222, v222, v8
  v_sub_f32 v223, v223, v8
  v_exp_f32 v12, v12
  v_sub_f32 v128, v128, v8
  v_sub_f32 v129, v129, v8
  v_sub_f32 v130, v130, v8
  v_sub_f32 v131, v131, v8
  v_sub_f32 v132, v132, v8
  v_sub_f32 v133, v133, v8
  v_sub_f32 v134, v134, v8
  v_sub_f32 v135, v135, v8
  v_sub_f32 v136, v136, v8
  v_sub_f32 v137, v137, v8
  v_sub_f32 v138, v138, v8
  v_sub_f32 v139, v139, v8
  v_sub_f32 v140, v140, v8
  v_sub_f32 v141, v141, v8
  v_sub_f32 v142, v142, v8
  v_sub_f32 v143, v143, v8
  v_sub_f32 v144, v144, v8
  v_sub_f32 v145, v145, v8
  v_sub_f32 v146, v146, v8
  v_sub_f32 v147, v147, v8
  v_sub_f32 v148, v148, v8
  v_sub_f32 v149, v149, v8
  v_sub_f32 v150, v150, v8
  v_sub_f32 v151, v151, v8
  v_sub_f32 v152, v152, v8
  v_sub_f32 v153, v153, v8
  v_sub_f32 v154, v154, v8
  v_sub_f32 v155, v155, v8
  v_sub_f32 v156, v156, v8
  v_sub_f32 v157, v157, v8
  v_sub_f32 v158, v158, v8
  v_sub_f32 v159, v159, v8
  v_mul_f32 v10, v12, v10
  v_mul_f32 v11, v12, v11
  s_mov_b32 s65, 1
  s_branch K1_R2
K1_SO3:
  s_nop 7
  s_nop 7
  v_mul_f32 v64, v12, v64
  v_mul_f32 v65, v12, v65
  v_mul_f32 v66, v12, v66
  v_mul_f32 v67, v12, v67
  v_mul_f32 v68, v12, v68
  v_mul_f32 v69, v12, v69
  v_mul_f32 v70, v12, v70
  v_mul_f32 v71, v12, v71
  v_mul_f32 v72, v12, v72
  v_mul_f32 v73, v12, v73
  v_mul_f32 v74, v12, v74
  v_mul_f32 v75, v12, v75
  v_mul_f32 v76, v12, v76
  v_mul_f32 v77, v12, v77
  v_mul_f32 v78, v12, v78
  v_mul_f32 v79, v12, v79
  v_mul_f32 v80, v12, v80
  v_mul_f32 v81, v12, v81
  v_mul_f32 v82, v12, v82
  v_mul_f32 v83, v12, v83
  v_mul_f32 v84, v12, v84
  v_mul_f32 v85, v12, v85
  v_mul_f32 v86, v12, v86
  v_mul_f32 v87, v12, v87
  v_mul_f32 v88, v12, v88
  v_mul_f32 v89, v12, v89
  v_mul_f32 v90, v12, v90
  v_mul_f32 v91, v12, v91
  v_mul_f32 v92, v12, v92
  v_mul_f32 v93, v12, v93
  v_mul_f32 v94, v12, v94
  v_mul_f32 v95, v12, v95
  v_mul_f32 v96, v12, v96
  v_mul_f32 v97, v12, v97
  v_mul_f32 v98, v12, v98
  v_mul_f32 v99, v12, v99
  v_mul_f32 v100, v12, v100
  v_mul_f32 v101, v12, v101
  v_mul_f32 v102, v12, v102
  v_mul_f32 v103, v12, v103
  v_mul_f32 v104, v12, v104
  v_mul_f32 v105, v12, v105
  v_mul_f32 v106, v12, v106
  v_mul_f32 v107, v12, v107
  v_mul_f32 v108, v12, v108
  v_mul_f32 v109, v12, v109
  v_mul_f32 v110, v12, v110
  v_mul_f32 v111, v12, v111
  v_mul_f32 v112, v12, v112
  v_mul_f32 v113, v12, v113
  v_mul_f32 v114, v12, v114
  v_mul_f32 v115, v12, v115
  v_mul_f32 v116, v12, v116
  v_mul_f32 v117, v12, v117
  v_mul_f32 v118, v12, v118
  v_mul_f32 v119, v12, v119
  v_mul_f32 v120, v12, v120
  v_mul_f32 v121, v12, v121
  v_mul_f32 v122, v12, v122
  v_mul_f32 v123, v12, v123
  v_mul_f32 v124, v12, v124
  v_mul_f32 v125, v12, v125
  v_mul_f32 v126, v12, v126
  v_mul_f32 v127, v12, v127
  s_nop 1
  s_branch K1_S3
K1_RO3:
  v_max_f32 v8, 0, v8
  v_sub_f32 v12, 0, v8
  v_sub_f32 v208, v208, v8
  v_sub_f32 v209, v209, v8
  v_sub_f32 v210, v210, v8
  v_sub_f32 v211, v211, v8
  v_sub_f32 v212, v212, v8
  v_sub_f32 v213, v213, v8
  v_sub_f32 v214, v214, v8
  v_sub_f32 v215, v215, v8
  v_sub_f32 v216, v216, v8
  v_sub_f32 v217, v217, v8
  v_sub_f32 v218, v218, v8
  v_sub_f32 v219, v219, v8
  v_sub_f32 v220, v220, v8
  v_sub_f32 v221, v221, v8
  v_sub_f32 v222, v222, v8
  v_sub_f32 v223, v223, v8
  v_exp_f32 v12, v12
  v_sub_f32 v160, v160, v8
  v_sub_f32 v161, v161, v8
  v_sub_f32 v162, v162, v8
  v_sub_f32 v163, v163, v8
  v_sub_f32 v164, v164, v8
  v_sub_f32 v165, v165, v8
  v_sub_f32 v166, v166, v8
  v_sub_f32 v167, v167, v8
  v_sub_f32 v168, v168, v8
  v_sub_f32 v169, v169, v8
  v_sub_f32 v170, v170, v8
  v_sub_f32 v171, v171, v8
  v_sub_f32 v172, v172, v8
  v_sub_f32 v173, v173, v8
  v_sub_f32 v174, v174, v8
  v_sub_f32 v175, v175, v8
  v_sub_f32 v176, v176, v8
  v_sub_f32 v177, v177, v8
  v_sub_f32 v178, v178, v8
  v_sub_f32 v179, v179, v8
  v_sub_f32 v180, v180, v8
  v_sub_f32 v181, v181, v8
  v_sub_f32 v182, v182, v8
  v_sub_f32 v183, v183, v8
  v_sub_f32 v184, v184, v8
  v_sub_f32 v185, v185, v8
  v_sub_f32 v186, v186, v8
  v_sub_f32 v187, v187, v8
  v_sub_f32 v188, v188, v8
  v_sub_f32 v189, v189, v8
  v_sub_f32 v190, v190, v8
  v_sub_f32 v191, v191, v8
  v_mul_f32 v10, v12, v10
  v_mul_f32 v11, v12, v11
  s_mov_b32 s65, 1
  s_branch K1_R3
K1_SO4:
  s_nop 7
  s_nop 7
  v_mul_f32 v64, v12, v64
  v_mul_f32 v65, v12, v65
  v_mul_f32 v66, v12, v66
  v_mul_f32 v67, v12, v67
  v_mul_f32 v68, v12, v68
  v_mul_f32 v69, v12, v69
  v_mul_f32 v70, v12, v70
  v_mul_f32 v71, v12, v71
  v_mul_f32 v72, v12, v72
  v_mul_f32 v73, v12, v73
  v_mul_f32 v74, v12, v74
  v_mul_f32 v75, v12, v75
  v_mul_f32 v76, v12, v76
  v_mul_f32 v77, v12, v77
  v_mul_f32 v78, v12, v78
  v_mul_f32 v79, v12, v79
  v_mul_f32 v80, v12, v80
  v_mul_f32 v81, v12, v81
  v_mul_f32 v82, v12, v82
  v_mul_f32 v83, v12, v83
  v_mul_f32 v84, v12, v84
  v_mul_f32 v85, v12, v85
  v_mul_f32 v86, v12, v86
  v_mul_f32 v87, v12, v87
  v_mul_f32 v88, v12, v88
  v_mul_f32 v89, v12, v89
  v_mul_f32 v90, v12, v90
  v_mul_f32 v91, v12, v91
  v_mul_f32 v92, v12, v92
  v_mul_f32 v93, v12, v93
  v_mul_f32 v94, v12, v94
  v_mul_f32 v95, v12, v95
  v_mul_f32 v96, v12, v96
  v_mul_f32 v97, v12, v97
  v_mul_f32 v98, v12, v98
  v_mul_f32 v99, v12, v99
  v_mul_f32 v100, v12, v100
  v_mul_f32 v101, v12, v101
  v_mul_f32 v102, v12, v102
  v_mul_f32 v103, v12, v103
  v_mul_f32 v104, v12, v104
  v_mul_f32 v105, v12, v105
  v_mul_f32 v106, v12, v106
  v_mul_f32 v107, v12, v107
  v_mul_f32 v108, v12, v108
  v_mul_f32 v109, v12, v109
  v_mul_f32 v110, v12, v110
  v_mul_f32 v111, v12, v111
  v_mul_f32 v112, v12, v112
  v_mul_f32 v113, v12, v113
  v_mul_f32 v114, v12, v114
  v_mul_f32 v115, v12, v115
  v_mul_f32 v116, v12, v116
  v_mul_f32 v117, v12, v117
  v_mul_f32 v118, v12, v118
  v_mul_f32 v119, v12, v119
  v_mul_f32 v120, v12, v120
  v_mul_f32 v121, v12, v121
  v_mul_f32 v122, v12, v122
  v_mul_f32 v123, v12, v123
  v_mul_f32 v124, v12, v124
  v_mul_f32 v125, v12, v125
  v_mul_f32 v126, v12, v126
  v_mul_f32 v127, v12, v127
  s_nop 1
  s_branch K1_S4
K1_RO4:
  v_max_f32 v8, 0, v8
  v_sub_f32 v12, 0, v8
  v_sub_f32 v208, v208, v8
  v_sub_f32 v209, v209, v8
  v_sub_f32 v210, v210, v8
  v_sub_f32 v211, v211, v8
  v_sub_f32 v212, v212, v8
  v_sub_f32 v213, v213, v8
  v_sub_f32 v214, v214, v8
  v_sub_f32 v215, v215, v8
  v_sub_f32 v216, v216, v8
  v_sub_f32 v217, v217, v8
  v_sub_f32 v218, v218, v8
  v_sub_f32 v219, v219, v8
  v_sub_f32 v220, v220, v8
  v_sub_f32 v221, v221, v8
  v_sub_f32 v222, v222, v8
  v_sub_f32 v223, v223, v8
  v_exp_f32 v12, v12
  v_sub_f32 v128, v128, v8
  v_sub_f32 v129, v129, v8
  v_sub_f32 v130, v130, v8
  v_sub_f32 v131, v131, v8
  v_sub_f32 v132, v132, v8
  v_sub_f32 v133, v133, v8
  v_sub_f32 v134, v134, v8
  v_sub_f32 v135, v135, v8
  v_sub_f32 v136, v136, v8
  v_sub_f32 v137, v137, v8
  v_sub_f32 v138, v138, v8
  v_sub_f32 v139, v139, v8
  v_sub_f32 v140, v140, v8
  v_sub_f32 v141, v141, v8
  v_sub_f32 v142, v142, v8
  v_sub_f32 v143, v143, v8
  v_sub_f32 v144, v144, v8
  v_sub_f32 v145, v145, v8
  v_sub_f32 v146, v146, v8
  v_sub_f32 v147, v147, v8
  v_sub_f32 v148, v148, v8
  v_sub_f32 v149, v149, v8
  v_sub_f32 v150, v150, v8
  v_sub_f32 v151, v151, v8
  v_sub_f32 v152, v152, v8
  v_sub_f32 v153, v153, v8
  v_sub_f32 v154, v154, v8
  v_sub_f32 v155, v155, v8
  v_sub_f32 v156, v156, v8
  v_sub_f32 v157, v157, v8
  v_sub_f32 v158, v158, v8
  v_sub_f32 v159, v159, v8
  v_mul_f32 v10, v12, v10
  v_mul_f32 v11, v12, v11
  s_mov_b32 s65, 1
  s_branch K1_R4
K1_SO5:
  s_nop 7
  s_nop 7
  v_mul_f32 v64, v12, v64
  v_mul_f32 v65, v12, v65
  v_mul_f32 v66, v12, v66
  v_mul_f32 v67, v12, v67
  v_mul_f32 v68, v12, v68
  v_mul_f32 v69, v12, v69
  v_mul_f32 v70, v12, v70
  v_mul_f32 v71, v12, v71
  v_mul_f32 v72, v12, v72
  v_mul_f32 v73, v12, v73
  v_mul_f32 v74, v12, v74
  v_mul_f32 v75, v12, v75
  v_mul_f32 v76, v12, v76
  v_mul_f32 v77, v12, v77
  v_mul_f32 v78, v12, v78
  v_mul_f32 v79, v12, v79
  v_mul_f32 v80, v12, v80
  v_mul_f32 v81, v12, v81
  v_mul_f32 v82, v12, v82
  v_mul_f32 v83, v12, v83
  v_mul_f32 v84, v12, v84
  v_mul_f32 v85, v12, v85
  v_mul_f32 v86, v12, v86
  v_mul_f32 v87, v12, v87
  v_mul_f32 v88, v12, v88
  v_mul_f32 v89, v12, v89
  v_mul_f32 v90, v12, v90
  v_mul_f32 v91, v12, v91
  v_mul_f32 v92, v12, v92
  v_mul_f32 v93, v12, v93
  v_mul_f32 v94, v12, v94
  v_mul_f32 v95, v12, v95
  v_mul_f32 v96, v12, v96
  v_mul_f32 v97, v12, v97
  v_mul_f32 v98, v12, v98
  v_mul_f32 v99, v12, v99
  v_mul_f32 v100, v12, v100
  v_mul_f32 v101, v12, v101
  v_mul_f32 v102, v12, v102
  v_mul_f32 v103, v12, v103
  v_mul_f32 v104, v12, v104
  v_mul_f32 v105, v12, v105
  v_mul_f32 v106, v12, v106
  v_mul_f32 v107, v12, v107
  v_mul_f32 v108, v12, v108
  v_mul_f32 v109, v12, v109
  v_mul_f32 v110, v12, v110
  v_mul_f32 v111, v12, v111
  v_mul_f32 v112, v12, v112
  v_mul_f32 v113, v12, v113
  v_mul_f32 v114, v12, v114
  v_mul_f32 v115, v12, v115
  v_mul_f32 v116, v12, v116
  v_mul_f32 v117, v12, v117
  v_mul_f32 v118, v12, v118
  v_mul_f32 v119, v12, v119
  v_mul_f32 v120, v12, v120
  v_mul_f32 v121, v12, v121
  v_mul_f32 v122, v12, v122
  v_mul_f32 v123, v12, v123
  v_mul_f32 v124, v12, v124
  v_mul_f32 v125, v12, v125
  v_mul_f32 v126, v12, v126
  v_mul_f32 v127, v12, v127
  s_nop 1
  s_branch K1_S5
K1_RO5:
  v_max_f32 v8, 0, v8
  v_sub_f32 v12, 0, v8
  v_sub_f32 v208, v208, v8
  v_sub_f32 v209, v209, v8
  v_sub_f32 v210, v210, v8
  v_sub_f32 v211, v211, v8
  v_sub_f32 v212, v212, v8
  v_sub_f32 v213, v213, v8
  v_sub_f32 v214, v214, v8
  v_sub_f32 v215, v215, v8
  v_sub_f32 v216, v216, v8
  v_sub_f32 v217, v217, v8
  v_sub_f32 v218, v218, v8
  v_sub_f32 v219, v219, v8
  v_sub_f32 v220, v220, v8
  v_sub_f32 v221, v221, v8
  v_sub_f32 v222, v222, v8
  v_sub_f32 v223, v223, v8
  v_exp_f32 v12, v12
  v_sub_f32 v160, v160, v8
  v_sub_f32 v161, v161, v8
  v_sub_f32 v162, v162, v8
  v_sub_f32 v163, v163, v8
  v_sub_f32 v164, v164, v8
  v_sub_f32 v165, v165, v8
  v_sub_f32 v166, v166, v8
  v_sub_f32 v167, v167, v8
  v_sub_f32 v168, v168, v8
  v_sub_f32 v169, v169, v8
  v_sub_f32 v170, v170, v8
  v_sub_f32 v171, v171, v8
  v_sub_f32 v172, v172, v8
  v_sub_f32 v173, v173, v8
  v_sub_f32 v174, v174, v8
  v_sub_f32 v175, v175, v8
  v_sub_f32 v176, v176, v8
  v_sub_f32 v177, v177, v8
  v_sub_f32 v178, v178, v8
  v_sub_f32 v179, v179, v8
  v_sub_f32 v180, v180, v8
  v_sub_f32 v181, v181, v8
  v_sub_f32 v182, v182, v8
  v_sub_f32 v183, v183, v8
  v_sub_f32 v184, v184, v8
  v_sub_f32 v185, v185, v8
  v_sub_f32 v186, v186, v8
  v_sub_f32 v187, v187, v8
  v_sub_f32 v188, v188, v8
  v_sub_f32 v189, v189, v8
  v_sub_f32 v190, v190, v8
  v_sub_f32 v191, v191, v8
  v_mul_f32 v10, v12, v10
  v_mul_f32 v11, v12, v11
  s_mov_b32 s65, 1
  s_branch K1_R5
K1_SO6:
  s_nop 7
  s_nop 7
  v_mul_f32 v64, v12, v64
  v_mul_f32 v65, v12, v65
  v_mul_f32 v66, v12, v66
  v_mul_f32 v67, v12, v67
  v_mul_f32 v68, v12, v68
  v_mul_f32 v69, v12, v69
  v_mul_f32 v70, v12, v70
  v_mul_f32 v71, v12, v71
  v_mul_f32 v72, v12, v72
  v_mul_f32 v73, v12, v73
  v_mul_f32 v74, v12, v74
  v_mul_f32 v75, v12, v75
  v_mul_f32 v76, v12, v76
  v_mul_f32 v77, v12, v77
  v_mul_f32 v78, v12, v78
  v_mul_f32 v79, v12, v79
  v_mul_f32 v80, v12, v80
  v_mul_f32 v81, v12, v81
  v_mul_f32 v82, v12, v82
  v_mul_f32 v83, v12, v83
  v_mul_f32 v84, v12, v84
  v_mul_f32 v85, v12, v85
  v_mul_f32 v86, v12, v86
  v_mul_f32 v87, v12, v87
  v_mul_f32 v88, v12, v88
  v_mul_f32 v89, v12, v89
  v_mul_f32 v90, v12, v90
  v_mul_f32 v91, v12, v91
  v_mul_f32 v92, v12, v92
  v_mul_f32 v93, v12, v93
  v_mul_f32 v94, v12, v94
  v_mul_f32 v95, v12, v95
  v_mul_f32 v96, v12, v96
  v_mul_f32 v97, v12, v97
  v_mul_f32 v98, v12, v98
  v_mul_f32 v99, v12, v99
  v_mul_f32 v100, v12, v100
  v_mul_f32 v101, v12, v101
  v_mul_f32 v102, v12, v102
  v_mul_f32 v103, v12, v103
  v_mul_f32 v104, v12, v104
  v_mul_f32 v105, v12, v105
  v_mul_f32 v106, v12, v106
  v_mul_f32 v107, v12, v107
  v_mul_f32 v108, v12, v108
  v_mul_f32 v109, v12, v109
  v_mul_f32 v110, v12, v110
  v_mul_f32 v111, v12, v111
  v_mul_f32 v112, v12, v112
  v_mul_f32 v113, v12, v113
  v_mul_f32 v114, v12, v114
  v_mul_f32 v115, v12, v115
  v_mul_f32 v116, v12, v116
  v_mul_f32 v117, v12, v117
  v_mul_f32 v118, v12, v118
  v_mul_f32 v119, v12, v119
  v_mul_f32 v120, v12, v120
  v_mul_f32 v121, v12, v121
  v_mul_f32 v122, v12, v122
  v_mul_f32 v123, v12, v123
  v_mul_f32 v124, v12, v124
  v_mul_f32 v125, v12, v125
  v_mul_f32 v126, v12, v126
  v_mul_f32 v127, v12, v127
  s_nop 1
  s_branch K1_S6
K1_RO6:
  v_max_f32 v8, 0, v8
  v_sub_f32 v12, 0, v8
  v_sub_f32 v208, v208, v8
  v_sub_f32 v209, v209, v8
  v_sub_f32 v210, v210, v8
  v_sub_f32 v211, v211, v8
  v_sub_f32 v212, v212, v8
  v_sub_f32 v213, v213, v8
  v_sub_f32 v214, v214, v8
  v_sub_f32 v215, v215, v8
  v_sub_f32 v216, v216, v8
  v_sub_f32 v217, v217, v8
  v_sub_f32 v218, v218, v8
  v_sub_f32 v219, v219, v8
  v_sub_f32 v220, v220, v8
  v_sub_f32 v221, v221, v8
  v_sub_f32 v222, v222, v8
  v_sub_f32 v223, v223, v8
  v_exp_f32 v12, v12
  v_sub_f32 v128, v128, v8
  v_sub_f32 v129, v129, v8
  v_sub_f32 v130, v130, v8
  v_sub_f32 v131, v131, v8
  v_sub_f32 v132, v132, v8
  v_sub_f32 v133, v133, v8
  v_sub_f32 v134, v134, v8
  v_sub_f32 v135, v135, v8
  v_sub_f32 v136, v136, v8
  v_sub_f32 v137, v137, v8
  v_sub_f32 v138, v138, v8
  v_sub_f32 v139, v139, v8
  v_sub_f32 v140, v140, v8
  v_sub_f32 v141, v141, v8
  v_sub_f32 v142, v142, v8
  v_sub_f32 v143, v143, v8
  v_sub_f32 v144, v144, v8
  v_sub_f32 v145, v145, v8
  v_sub_f32 v146, v146, v8
  v_sub_f32 v147, v147, v8
  v_sub_f32 v148, v148, v8
  v_sub_f32 v149, v149, v8
  v_sub_f32 v150, v150, v8
  v_sub_f32 v151, v151, v8
  v_sub_f32 v152, v152, v8
  v_sub_f32 v153, v153, v8
  v_sub_f32 v154, v154, v8
  v_sub_f32 v155, v155, v8
  v_sub_f32 v156, v156, v8
  v_sub_f32 v157, v157, v8
  v_sub_f32 v158, v158, v8
  v_sub_f32 v159, v159, v8
  v_mul_f32 v10, v12, v10
  v_mul_f32 v11, v12, v11
  s_mov_b32 s65, 1
  s_branch K1_R6
K1_SO7:
  s_nop 7
  s_nop 7
  v_mul_f32 v64, v12, v64
  v_mul_f32 v65, v12, v65
  v_mul_f32 v66, v12, v66
  v_mul_f32 v67, v12, v67
  v_mul_f32 v68, v12, v68
  v_mul_f32 v69, v12, v69
  v_mul_f32 v70, v12, v70
  v_mul_f32 v71, v12, v71
  v_mul_f32 v72, v12, v72
  v_mul_f32 v73, v12, v73
  v_mul_f32 v74, v12, v74
  v_mul_f32 v75, v12, v75
  v_mul_f32 v76, v12, v76
  v_mul_f32 v77, v12, v77
  v_mul_f32 v78, v12, v78
  v_mul_f32 v79, v12, v79
  v_mul_f32 v80, v12, v80
  v_mul_f32 v81, v12, v81
  v_mul_f32 v82, v12, v82
  v_mul_f32 v83, v12, v83
  v_mul_f32 v84, v12, v84
  v_mul_f32 v85, v12, v85
  v_mul_f32 v86, v12, v86
  v_mul_f32 v87, v12, v87
  v_mul_f32 v88, v12, v88
  v_mul_f32 v89, v12, v89
  v_mul_f32 v90, v12, v90
  v_mul_f32 v91, v12, v91
  v_mul_f32 v92, v12, v92
  v_mul_f32 v93, v12, v93
  v_mul_f32 v94, v12, v94
  v_mul_f32 v95, v12, v95
  v_mul_f32 v96, v12, v96
  v_mul_f32 v97, v12, v97
  v_mul_f32 v98, v12, v98
  v_mul_f32 v99, v12, v99
  v_mul_f32 v100, v12, v100
  v_mul_f32 v101, v12, v101
  v_mul_f32 v102, v12, v102
  v_mul_f32 v103, v12, v103
  v_mul_f32 v104, v12, v104
  v_mul_f32 v105, v12, v105
  v_mul_f32 v106, v12, v106
  v_mul_f32 v107, v12, v107
  v_mul_f32 v108, v12, v108
  v_mul_f32 v109, v12, v109
  v_mul_f32 v110, v12, v110
  v_mul_f32 v111, v12, v111
  v_mul_f32 v112, v12, v112
  v_mul_f32 v113, v12, v113
  v_mul_f32 v114, v12, v114
  v_mul_f32 v115, v12, v115
  v_mul_f32 v116, v12, v116
  v_mul_f32 v117, v12, v117
  v_mul_f32 v118, v12, v118
  v_mul_f32 v119, v12, v119
  v_mul_f32 v120, v12, v120
  v_mul_f32 v121, v12, v121
  v_mul_f32 v122, v12, v122
  v_mul_f32 v123, v12, v123
  v_mul_f32 v124, v12, v124
  v_mul_f32 v125, v12, v125
  v_mul_f32 v126, v12, v126
  v_mul_f32 v127, v12, v127
  s_nop 1
  s_branch K1_S7
K1_RO7:
  v_max_f32 v8, 0, v8
  v_sub_f32 v12, 0, v8
  v_sub_f32 v208, v208, v8
  v_sub_f32 v209, v209, v8
  v_sub_f32 v210, v210, v8
  v_sub_f32 v211, v211, v8
  v_sub_f32 v212, v212, v8
  v_sub_f32 v213, v213, v8
  v_sub_f32 v214, v214, v8
  v_sub_f32 v215, v215, v8
  v_sub_f32 v216, v216, v8
  v_sub_f32 v217, v217, v8
  v_sub_f32 v218, v218, v8
  v_sub_f32 v219, v219, v8
  v_sub_f32 v220, v220, v8
  v_sub_f32 v221, v221, v8
  v_sub_f32 v222, v222, v8
  v_sub_f32 v223, v223, v8
  v_exp_f32 v12, v12
  v_sub_f32 v160, v160, v8
  v_sub_f32 v161, v161, v8
  v_sub_f32 v162, v162, v8
  v_sub_f32 v163, v163, v8
  v_sub_f32 v164, v164, v8
  v_sub_f32 v165, v165, v8
  v_sub_f32 v166, v166, v8
  v_sub_f32 v167, v167, v8
  v_sub_f32 v168, v168, v8
  v_sub_f32 v169, v169, v8
  v_sub_f32 v170, v170, v8
  v_sub_f32 v171, v171, v8
  v_sub_f32 v172, v172, v8
  v_sub_f32 v173, v173, v8
  v_sub_f32 v174, v174, v8
  v_sub_f32 v175, v175, v8
  v_sub_f32 v176, v176, v8
  v_sub_f32 v177, v177, v8
  v_sub_f32 v178, v178, v8
  v_sub_f32 v179, v179, v8
  v_sub_f32 v180, v180, v8
  v_sub_f32 v181, v181, v8
  v_sub_f32 v182, v182, v8
  v_sub_f32 v183, v183, v8
  v_sub_f32 v184, v184, v8
  v_sub_f32 v185, v185, v8
  v_sub_f32 v186, v186, v8
  v_sub_f32 v187, v187, v8
  v_sub_f32 v188, v188, v8
  v_sub_f32 v189, v189, v8
  v_sub_f32 v190, v190, v8
  v_sub_f32 v191, v191, v8
  v_mul_f32 v10, v12, v10
  v_mul_f32 v11, v12, v11
  s_mov_b32 s65, 1
  s_branch K1_R7
K1_SO8:
  s_nop 7
  s_nop 7
  v_mul_f32 v64, v12, v64
  v_mul_f32 v65, v12, v65
  v_mul_f32 v66, v12, v66
  v_mul_f32 v67, v12, v67
  v_mul_f32 v68, v12, v68
  v_mul_f32 v69, v12, v69
  v_mul_f32 v70, v12, v70
  v_mul_f32 v71, v12, v71
  v_mul_f32 v72, v12, v72
  v_mul_f32 v73, v12, v73
  v_mul_f32 v74, v12, v74
  v_mul_f32 v75, v12, v75
  v_mul_f32 v76, v12, v76
  v_mul_f32 v77, v12, v77
  v_mul_f32 v78, v12, v78
  v_mul_f32 v79, v12, v79
  v_mul_f32 v80, v12, v80
  v_mul_f32 v81, v12, v81
  v_mul_f32 v82, v12, v82
  v_mul_f32 v83, v12, v83
  v_mul_f32 v84, v12, v84
  v_mul_f32 v85, v12, v85
  v_mul_f32 v86, v12, v86
  v_mul_f32 v87, v12, v87
  v_mul_f32 v88, v12, v88
  v_mul_f32 v89, v12, v89
  v_mul_f32 v90, v12, v90
  v_mul_f32 v91, v12, v91
  v_mul_f32 v92, v12, v92
  v_mul_f32 v93, v12, v93
  v_mul_f32 v94, v12, v94
  v_mul_f32 v95, v12, v95
  v_mul_f32 v96, v12, v96
  v_mul_f32 v97, v12, v97
  v_mul_f32 v98, v12, v98
  v_mul_f32 v99, v12, v99
  v_mul_f32 v100, v12, v100
  v_mul_f32 v101, v12, v101
  v_mul_f32 v102, v12, v102
  v_mul_f32 v103, v12, v103
  v_mul_f32 v104, v12, v104
  v_mul_f32 v105, v12, v105
  v_mul_f32 v106, v12, v106
  v_mul_f32 v107, v12, v107
  v_mul_f32 v108, v12, v108
  v_mul_f32 v109, v12, v109
  v_mul_f32 v110, v12, v110
  v_mul_f32 v111, v12, v111
  v_mul_f32 v112, v12, v112
  v_mul_f32 v113, v12, v113
  v_mul_f32 v114, v12, v114
  v_mul_f32 v115, v12, v115
  v_mul_f32 v116, v12, v116
  v_mul_f32 v117, v12, v117
  v_mul_f32 v118, v12, v118
  v_mul_f32 v119, v12, v119
  v_mul_f32 v120, v12, v120
  v_mul_f32 v121, v12, v121
  v_mul_f32 v122, v12, v122
  v_mul_f32 v123, v12, v123
  v_mul_f32 v124, v12, v124
  v_mul_f32 v125, v12, v125
  v_mul_f32 v126, v12, v126
  v_mul_f32 v127, v12, v127
  s_nop 1
  s_branch K1_S8
L_END:
  s_endpgm
.section .rodata,"a"
.p2align 6
.amdhsa_kernel standalone__mha_block_cached__near_ridge_kernel
  .amdhsa_next_free_vgpr 256
  .amdhsa_next_free_sgpr 102
  .amdhsa_accum_offset 256
  .amdhsa_group_segment_fixed_size 0
  .amdhsa_kernarg_size 64
  .amdhsa_user_sgpr_count 2
  .amdhsa_user_sgpr_kernarg_segment_ptr 1
  .amdhsa_system_sgpr_workgroup_id_x 1
.end_amdhsa_kernel
```
